```python
import torch

def _softmax(x, axis=-1):
    return torch.softmax(x, dim=axis)
def _gelu(x):
    return torch.nn.functional.gelu(x, approximate="tanh")
def _silu(x):
    return torch.nn.functional.silu(x)
def _sigmoid(x):
    return torch.sigmoid(x)
def _layernorm(x, axis=-1, eps=1e-5):
    m = x.mean(dim=axis, keepdim=True)
    v = x.var(dim=axis, keepdim=True, unbiased=False)
    return (x - m) / torch.sqrt(v + eps)
def _scatter_add(tgt, idx, src, axis=0):
    return tgt.clone().index_add_(axis, idx, src)
def _segment_sum(src, seg, n):
    out = torch.zeros((n,) + src.shape[1:], dtype=src.dtype)
    return out.index_add_(0, seg, src)
def _pad(x, pw):
    flat = tuple(v for pair in reversed(pw) for v in pair)
    return torch.nn.functional.pad(x, flat)

kernel_name = 'standalone__mha_softmax__near_ridge'

def setup_inputs():

    _w = (lambda a: (lambda t: t.to(torch.bfloat16) if t.is_floating_point() else t)(torch.as_tensor(a)))
    B, H, Sq, Sk, D = 8, 32, 368, 1024, 128
    return {
        "q": _w((lambda *s: torch.randn(*s, dtype=torch.bfloat16) * 0.8)(B, H, Sq, D)),
        "k": _w((lambda *s: torch.randn(*s, dtype=torch.bfloat16) * 0.8)(B, H, Sk, D)),
        "v": _w((lambda *s: torch.randn(*s, dtype=torch.bfloat16) * 0.05)(B, H, Sk, D)),
    }

def reference(q, k, v):
    scale = q.shape[-1] ** -0.5
    scores = torch.einsum("bhqd,bhkd->bhqk", q, k) * scale
    p = _softmax(scores, axis=-1)
    return torch.einsum("bhqk,bhkd->bhqd", p, v)
```

```asm
; @launch grid=(256,1,1) block=(256,1,1) lds=163840
.amdgcn_target "amdgcn-amd-amdhsa--gfx950"
.text
.globl standalone__mha_softmax__near_ridge_kernel
.p2align 8
.type standalone__mha_softmax__near_ridge_kernel,@function
standalone__mha_softmax__near_ridge_kernel:
    s_load_dwordx4 s[4:7], s[0:1], 0
    s_load_dwordx4 s[12:15], s[0:1], 16
    s_cmpk_ge_u32 s2, 256
    s_cbranch_scc1 L_end
    s_getpc_b64 s[34:35]
L_pc:
    v_mov_b32 v41, 0
    v_lshlrev_b32 v46, 7, v0
    v_min_u32 v40, L_fin-L_pc, v46
    v_lshl_add_u64 v[42:43], v[40:41], 0, s[34:35]
    global_load_dword v58, v[42:43], off
    v_lshrrev_b32 v1, 6, v0
    s_lshl_b32 s3, s2, 18
    v_readfirstlane_b32 s20, v1
    v_and_b32 v0, 63, v0
    s_mul_i32 s35, s2, 94208
    s_mov_b32 s10, 0x40000
    s_mov_b32 s11, 0x20000
    s_mov_b32 s18, 94208
    s_mov_b32 s19, s11
    s_and_b32 s26, s20, 1
    s_lshl_b32 s23, s26, 5
    v_lshrrev_b32 v1, 4, v0
    v_lshlrev_b32 v3, 2, v1
    v_xor_b32 v3, v3, v0
    v_and_b32 v3, 15, v3
    v_lshlrev_b32 v3, 4, v3
    v_lshl_add_u32 v3, v1, 8, v3
    v_xor_b32 v3, s23, v3
    v_xor_b32 v234, 32, v3
    s_and_b32 s27, s20, 2
    s_lshl1_add_u32 s26, s27, s26
    s_lshl_b32 s26, s26, 10
    s_add_u32 s27, s26, 8192
    s_add_u32 s21, s26, 16384
    s_mul_i32 s29, s20, 24576
    s_lshl_b32 s28, s20, 12
    s_waitcnt lgkmcnt(0)
    s_add_u32 s8, s6, s3
    s_addc_u32 s9, s7, 0
    s_add_u32 s4, s4, s35
    s_addc_u32 s5, s5, 0
    s_mov_b32 s6, s18
    s_mov_b32 s7, s19
    s_add_u32 m0, s28, 0x8000
    s_nop 0
    buffer_load_dwordx4 v3, s[4:7], s29 offen offset:0 nt lds
    buffer_load_dwordx4 v234, s[4:7], s29 offen offset:1024 nt lds
    buffer_load_dwordx4 v3, s[4:7], s29 offen offset:2048 nt lds
    buffer_load_dwordx4 v234, s[4:7], s29 offen offset:3072 nt lds
    s_add_u32 s29, s29, 4096
    s_add_u32 m0, s26, 0x0
    s_nop 0
    buffer_load_dwordx4 v3, s[8:11], s26 offen nt lds
    buffer_load_dwordx4 v3, s[8:11], s26 offen offset:2048 nt lds
    s_add_u32 m0, s27, 0x0
    s_nop 0
    buffer_load_dwordx4 v3, s[8:11], s27 offen nt lds
    buffer_load_dwordx4 v3, s[8:11], s27 offen offset:2048 nt lds
    s_add_u32 s16, s14, s35
    s_addc_u32 s17, s15, 0
    s_add_u32 s12, s12, s3
    s_addc_u32 s13, s13, 0
    s_mov_b32 s14, s10
    s_mov_b32 s15, s11
    s_mov_b32 s25, 0
    v_mov_b32 v16, 0x7f800000
    v_mov_b32 v20, v16
    v_mov_b32 v24, v16
    v_mov_b32 v28, v16
    v_mov_b32 v32, v16
    v_mov_b32 v36, v16
L_restart:
    s_add_u32 m0, s26, 0x10000
    s_nop 0
    buffer_load_dwordx4 v3, s[12:15], s26 offen nt lds
    buffer_load_dwordx4 v3, s[12:15], s26 offen offset:2048 nt lds
    s_add_u32 m0, s27, 0x10000
    s_nop 0
    buffer_load_dwordx4 v3, s[12:15], s27 offen nt lds
    buffer_load_dwordx4 v3, s[12:15], s27 offen offset:2048 nt lds
    v_mov_b32 v224, 0
    v_mov_b32 v225, 0
    v_mov_b32 v228, 0
    v_mov_b32 v229, 0
    v_mov_b32 v232, 0
    v_mov_b32 v233, 0
    v_bfe_u32 v40, v0, 1, 3
    v_lshlrev_b32 v41, 1, v1
    v_and_b32 v42, 1, v0
    v_lshlrev_b32 v42, 4, v42
    v_mov_b32 v43, 0x3e03
    v_mov_b32 v44, 0xb9d8
    v_cmp_eq_u32 vcc, v40, v41
    v_lshlrev_b32 v43, v42, v43
    v_lshlrev_b32 v44, v42, v44
    v_or_b32 v41, 1, v41
    v_cndmask_b32 v226, 0, v43, vcc
    v_cndmask_b32 v230, 0, v44, vcc
    v_cmp_eq_u32 vcc, v40, v41
    s_nop 1
    v_cndmask_b32 v227, 0, v43, vcc
    v_cndmask_b32 v231, 0, v44, vcc
    v_and_b32 v40, 3, v0
    v_lshlrev_b32 v40, 2, v40
    v_lshrrev_b32 v41, 1, v0
    v_and_b32 v41, 2, v41
    v_or_b32 v40, v40, v41
    v_xor_b32 v40, v40, v1
    v_lshlrev_b32 v40, 4, v40
    v_and_b32 v41, 15, v0
    v_lshl_add_u32 v4, v41, 8, v40
    v_xor_b32 v5, 64, v4
    v_xor_b32 v6, 128, v4
    v_xor_b32 v7, 192, v4
    v_and_b32 v40, 12, v0
    v_and_b32 v41, 1, v1
    v_lshlrev_b32 v41, 1, v41
    v_or_b32 v40, v40, v41
    v_lshlrev_b32 v40, 4, v40
    v_and_b32 v41, 3, v0
    v_lshlrev_b32 v41, 4, v41
    v_xor_b32 v40, v40, v41
    v_lshrrev_b32 v41, 2, v0
    v_lshl_add_u32 v40, v41, 8, v40
    v_add_u32 v8, 0x10000, v40
    v_xor_b32 v9, 64, v8
    v_xor_b32 v10, 128, v8
    v_xor_b32 v11, 192, v8
    v_and_b32 v40, 3, v0
    v_cmp_eq_u32 vcc, 0, v40
    v_mov_b32 v41, 0x3f803f80
    s_or_b32 s23, s23, s28
    v_cndmask_b32 v40, 0, v41, vcc
    v_accvgpr_write_b32 a248, v40
    v_accvgpr_write_b32 a249, v40
    v_accvgpr_write_b32 a250, v40
    v_accvgpr_write_b32 a251, v40
    v_xor_b32 v236, s23, v4
    v_xor_b32 v237, s23, v5
    v_xor_b32 v238, s23, v6
    v_xor_b32 v239, s23, v7
    v_and_b32 v40, 14, v0
    v_lshlrev_b32 v40, 8, v40
    v_and_b32 v41, 1, v0
    v_lshl_add_u32 v40, v41, 6, v40
    v_lshl_add_u32 v40, v1, 4, v40
    v_accvgpr_write_b32 a252, v40
    s_waitcnt vmcnt(8)
    ds_read_b128 a[0:3], v236 offset:32768
    ds_read_b128 a[4:7], v237 offset:32768
    ds_read_b128 a[8:11], v238 offset:32768
    ds_read_b128 a[12:15], v239 offset:32768
    s_add_u32 m0, s28, 0xc000
    s_nop 0
    buffer_load_dwordx4 v3, s[4:7], s29 offen offset:0 nt lds
    buffer_load_dwordx4 v234, s[4:7], s29 offen offset:1024 nt lds
    buffer_load_dwordx4 v3, s[4:7], s29 offen offset:2048 nt lds
    buffer_load_dwordx4 v234, s[4:7], s29 offen offset:3072 nt lds
    s_add_u32 s29, s29, 4096
    s_waitcnt lgkmcnt(3)
    v_mfma_f32_16x16x32_bf16 v[240:243], v[226:229], a[0:3], 0
    v_mfma_f32_16x16x32_bf16 v[240:243], v[230:233], a[0:3], v[240:243]
    v_mfma_f32_16x16x32_bf16 v[244:247], v[224:227], a[0:3], 0
    v_mfma_f32_16x16x32_bf16 v[244:247], v[228:231], a[0:3], v[244:247]
    s_waitcnt lgkmcnt(2)
    v_mfma_f32_16x16x32_bf16 v[248:251], v[226:229], a[4:7], 0
    v_mfma_f32_16x16x32_bf16 v[248:251], v[230:233], a[4:7], v[248:251]
    v_mfma_f32_16x16x32_bf16 v[252:255], v[224:227], a[4:7], 0
    v_mfma_f32_16x16x32_bf16 v[252:255], v[228:231], a[4:7], v[252:255]
    s_nop 0
    v_cvt_pk_bf16_f32 v240, v240, v241
    v_cvt_pk_bf16_f32 v242, v242, v243
    v_accvgpr_write_b32 a0, v240
    v_accvgpr_write_b32 a1, v242
    s_waitcnt lgkmcnt(1)
    v_mfma_f32_16x16x32_bf16 v[240:243], v[226:229], a[8:11], 0
    v_cvt_pk_bf16_f32 v244, v244, v245
    v_cvt_pk_bf16_f32 v246, v246, v247
    v_mfma_f32_16x16x32_bf16 v[240:243], v[230:233], a[8:11], v[240:243]
    v_accvgpr_write_b32 a2, v244
    v_accvgpr_write_b32 a3, v246
    v_mfma_f32_16x16x32_bf16 v[244:247], v[224:227], a[8:11], 0
    v_cvt_pk_bf16_f32 v248, v248, v249
    v_cvt_pk_bf16_f32 v250, v250, v251
    v_mfma_f32_16x16x32_bf16 v[244:247], v[228:231], a[8:11], v[244:247]
    v_accvgpr_write_b32 a4, v248
    v_accvgpr_write_b32 a5, v250
    s_waitcnt lgkmcnt(0)
    v_mfma_f32_16x16x32_bf16 v[248:251], v[226:229], a[12:15], 0
    v_cvt_pk_bf16_f32 v252, v252, v253
    v_cvt_pk_bf16_f32 v254, v254, v255
    v_mfma_f32_16x16x32_bf16 v[248:251], v[230:233], a[12:15], v[248:251]
    v_accvgpr_write_b32 a6, v252
    v_accvgpr_write_b32 a7, v254
    v_mfma_f32_16x16x32_bf16 v[252:255], v[224:227], a[12:15], 0
    v_cvt_pk_bf16_f32 v240, v240, v241
    v_cvt_pk_bf16_f32 v242, v242, v243
    v_mfma_f32_16x16x32_bf16 v[252:255], v[228:231], a[12:15], v[252:255]
    v_cvt_pk_bf16_f32 v244, v244, v245
    v_cvt_pk_bf16_f32 v246, v246, v247
    v_cvt_pk_bf16_f32 v248, v248, v249
    v_cvt_pk_bf16_f32 v250, v250, v251
    v_accvgpr_write_b32 a8, v240
    v_accvgpr_write_b32 a9, v242
    v_accvgpr_write_b32 a10, v244
    v_accvgpr_write_b32 a11, v246
    v_cvt_pk_bf16_f32 v252, v252, v253
    v_cvt_pk_bf16_f32 v254, v254, v255
    v_accvgpr_write_b32 a12, v248
    v_accvgpr_write_b32 a13, v250
    v_accvgpr_write_b32 a14, v252
    v_accvgpr_write_b32 a15, v254
    s_waitcnt vmcnt(8)
    s_add_u32 m0, s28, 0x18000
    s_nop 0
    buffer_load_dwordx4 v3, s[4:7], s29 offen offset:0 nt lds
    buffer_load_dwordx4 v234, s[4:7], s29 offen offset:1024 nt lds
    buffer_load_dwordx4 v3, s[4:7], s29 offen offset:2048 nt lds
    buffer_load_dwordx4 v234, s[4:7], s29 offen offset:3072 nt lds
    s_add_u32 s29, s29, 4096
    s_barrier
    ds_read_b128 a[96:99], v4 offset:0
    ds_read_b128 a[100:103], v5 offset:0
    ds_read_b128 a[104:107], v6 offset:0
    ds_read_b128 a[108:111], v7 offset:0
    ds_read_b128 a[112:115], v4 offset:4096
    ds_read_b128 a[116:119], v5 offset:4096
    ds_read_b128 a[120:123], v6 offset:4096
    ds_read_b128 a[124:127], v7 offset:4096
    ds_read_b128 a[128:131], v4 offset:8192
    ds_read_b128 a[132:135], v5 offset:8192
    ds_read_b128 a[136:139], v6 offset:8192
    ds_read_b128 a[140:143], v7 offset:8192
    ds_read_b128 a[144:147], v4 offset:12288
    ds_read_b128 a[148:151], v5 offset:12288
    ds_read_b128 a[152:155], v6 offset:12288
    ds_read_b128 a[156:159], v7 offset:12288
    s_cmp_eq_u32 s20, 3
    s_cbranch_scc1 L_pro5
    s_waitcnt lgkmcnt(15)
    v_mfma_f32_16x16x32_bf16 v[40:43], a[96:99], a[0:3], 0
    s_add_u32 m0, s28, 0x1c000
    v_mbcnt_lo_u32_b32 v14, -1, 0
    v_mbcnt_hi_u32_b32 v14, -1, v14
    s_waitcnt lgkmcnt(14)
    v_mfma_f32_16x16x32_bf16 v[40:43], a[100:103], a[4:7], v[40:43]
    s_mov_b32 s23, 0x4000
    v_lshrrev_b32 v13, 4, v14
    v_mul_u32_u24 v13, 20, v13
    s_waitcnt lgkmcnt(11)
    v_mfma_f32_16x16x32_bf16 v[40:43], a[104:107], a[8:11], v[40:43]
    s_mov_b32 s22, 14
    v_sub_u32 v14, v14, v13
    v_cmp_eq_u32 vcc, 0, v14
    v_mfma_f32_16x16x32_bf16 v[40:43], a[108:111], a[12:15], v[40:43]
    v_mov_b32 v12, 0x71800000
    v_mov_b32 v2, 0
    v_mfma_f32_16x16x32_bf16 v[44:47], a[112:115], a[0:3], 0
    s_waitcnt lgkmcnt(2)
    v_mfma_f32_16x16x32_bf16 v[44:47], a[116:119], a[4:7], v[44:47]
    v_mfma_f32_16x16x32_bf16 v[44:47], a[120:123], a[8:11], v[44:47]
    v_mfma_f32_16x16x32_bf16 v[44:47], a[124:127], a[12:15], v[44:47]
    s_nop 0
    v_max3_f32 v0, v40, v41, v42
    s_nop 5
    v_max3_f32 v1, v43, v44, v45
    v_max3_f32 v0, v0, v46, v47
    v_max_f32 v0, v0, v1
    v_mov_b32 v1, v0
    s_nop 1
    v_permlane32_swap_b32 v0, v1
    v_max_f32 v0, v0, v1
    v_mov_b32 v1, v0
    s_nop 1
    v_permlane16_swap_b32 v0, v1
    v_max_f32 v0, v0, v1
    v_min_f32 v16, -v0, v16
    v_add_f32 v16, 0xc1300000, v16
    v_mov_b32 v17, v16
    v_mov_b32 v18, v16
    v_mov_b32 v19, v16
    v_add_f32 v40, v40, v16
    v_add_f32 v41, v41, v16
    v_mfma_f32_16x16x32_bf16 v[48:51], a[128:131], a[0:3], v[16:19]
    v_add_f32 v42, v42, v16
    v_add_f32 v43, v43, v16
    v_mfma_f32_16x16x32_bf16 v[48:51], a[132:135], a[4:7], v[48:51]
    v_add_f32 v44, v44, v16
    v_add_f32 v45, v45, v16
    v_mfma_f32_16x16x32_bf16 v[48:51], a[136:139], a[8:11], v[48:51]
    v_add_f32 v46, v46, v16
    v_add_f32 v47, v47, v16
    v_mfma_f32_16x16x32_bf16 v[48:51], a[140:143], a[12:15], v[48:51]
    v_exp_f32 v40, v40
    v_mfma_f32_16x16x32_bf16 v[52:55], a[144:147], a[0:3], v[16:19]
    v_exp_f32 v41, v41
    v_mfma_f32_16x16x32_bf16 v[52:55], a[148:151], a[4:7], v[52:55]
    v_exp_f32 v42, v42
    s_waitcnt lgkmcnt(0)
    v_mfma_f32_16x16x32_bf16 v[52:55], a[152:155], a[8:11], v[52:55]
    v_exp_f32 v43, v43
    v_mfma_f32_16x16x32_bf16 v[52:55], a[156:159], a[12:15], v[52:55]
    s_waitcnt vmcnt(8)
    buffer_load_dwordx4 v3, s[4:7], s29 offen offset:0 nt lds
    buffer_load_dwordx4 v234, s[4:7], s29 offen offset:1024 nt lds
    buffer_load_dwordx4 v3, s[4:7], s29 offen offset:2048 nt lds
    buffer_load_dwordx4 v234, s[4:7], s29 offen offset:3072 nt lds
    s_barrier
    ds_read_b64_tr_b16 a[160:161], v8 offset:0
    ds_read_b64_tr_b16 a[162:163], v8 offset:4096
    ds_read_b64_tr_b16 a[164:165], v8 offset:8
    ds_read_b64_tr_b16 a[166:167], v8 offset:4104
    ds_read_b64_tr_b16 a[168:169], v9 offset:0
    ds_read_b64_tr_b16 a[170:171], v9 offset:4096
    ds_read_b64_tr_b16 a[172:173], v9 offset:8
    ds_read_b64_tr_b16 a[174:175], v9 offset:4104
    ds_read_b64_tr_b16 a[176:177], v10 offset:0
    ds_read_b64_tr_b16 a[178:179], v10 offset:4096
    ds_read_b64_tr_b16 a[180:181], v10 offset:8
    ds_read_b64_tr_b16 a[182:183], v10 offset:4104
    ds_read_b64_tr_b16 a[184:185], v11 offset:0
    ds_read_b64_tr_b16 a[186:187], v11 offset:4096
    ds_read_b64_tr_b16 a[188:189], v11 offset:8
    ds_read_b64_tr_b16 a[190:191], v11 offset:4104
    v_exp_f32 v44, v44
    s_waitcnt lgkmcnt(14)
    v_mfma_f32_16x16x32_bf16 v[192:195], a[160:163], a[160:163], 0
    ds_read_b64_tr_b16 a[192:193], v8 offset:8192
    v_cvt_pk_bf16_f32 v56, v40, v41
    s_waitcnt lgkmcnt(13)
    v_mfma_f32_16x16x32_bf16 v[196:199], a[164:167], a[164:167], 0
    ds_read_b64_tr_b16 a[194:195], v8 offset:12288
    v_cvt_pk_bf16_f32 v57, v42, v43
    s_waitcnt lgkmcnt(12)
    v_mfma_f32_16x16x32_bf16 v[200:203], a[168:171], a[168:171], 0
    ds_read_b64_tr_b16 a[196:197], v8 offset:8200
    s_waitcnt lgkmcnt(11)
    v_mfma_f32_16x16x32_bf16 v[204:207], a[172:175], a[172:175], 0
    ds_read_b64_tr_b16 a[198:199], v8 offset:12296
    s_waitcnt lgkmcnt(10)
    v_mfma_f32_16x16x32_bf16 v[208:211], a[176:179], a[176:179], 0
    ds_read_b64_tr_b16 a[200:201], v9 offset:8192
    s_waitcnt lgkmcnt(9)
    v_mfma_f32_16x16x32_bf16 v[212:215], a[180:183], a[180:183], 0
    ds_read_b64_tr_b16 a[202:203], v9 offset:12288
    s_waitcnt lgkmcnt(8)
    v_mfma_f32_16x16x32_bf16 v[216:219], a[184:187], a[184:187], 0
    ds_read_b64_tr_b16 a[204:205], v9 offset:8200
    v_min3_f32 v192, v192, v196, v200
    s_waitcnt lgkmcnt(7)
    v_mfma_f32_16x16x32_bf16 v[220:223], a[188:191], a[188:191], 0
    ds_read_b64_tr_b16 a[206:207], v9 offset:12296
    ds_read_b64_tr_b16 a[208:209], v10 offset:8192
    ds_read_b64_tr_b16 a[210:211], v10 offset:12288
    ds_read_b64_tr_b16 a[212:213], v10 offset:8200
    ds_read_b64_tr_b16 a[214:215], v10 offset:12296
    ds_read_b64_tr_b16 a[216:217], v11 offset:8192
    ds_read_b64_tr_b16 a[218:219], v11 offset:12288
    ds_read_b64_tr_b16 a[220:221], v11 offset:8200
    ds_read_b64_tr_b16 a[222:223], v11 offset:12296
    s_waitcnt vmcnt(8)
    ds_read_b128 a[16:19], v236 offset:49152
    s_add_u32 s29, s29, 4096
    ds_read_b128 a[20:23], v237 offset:49152
    ds_read_b128 a[24:27], v238 offset:49152
    s_add_u32 m0, s28, 0x20000
    ds_read_b128 a[28:31], v239 offset:49152
    buffer_load_dwordx4 v3, s[4:7], s29 offen offset:0 nt lds
    buffer_load_dwordx4 v234, s[4:7], s29 offen offset:1024 nt lds
    buffer_load_dwordx4 v3, s[4:7], s29 offen offset:2048 nt lds
    buffer_load_dwordx4 v234, s[4:7], s29 offen offset:3072 nt lds
    s_add_u32 s29, s29, 4096
    s_cmp_lg_u32 s25, 0
    s_cselect_b32 s34, 0, 0x3fc00000
    s_add_u32 m0, s28, 0x24000
    v_min3_f32 v193, v193, v197, v201
    v_min3_f32 v194, v194, v198, v202
    v_min3_f32 v195, v195, v199, v203
    v_min3_f32 v204, v204, v208, v212
    v_min3_f32 v192, v192, v216, v220
    v_min3_f32 v205, v205, v209, v213
    v_min3_f32 v193, v193, v217, v221
    v_min3_f32 v206, v206, v210, v214
    v_min3_f32 v194, v194, v218, v222
    v_min3_f32 v207, v207, v211, v215
    v_min3_f32 v195, v195, v219, v223
    v_min3_f32 v192, v192, v204, v12
    v_min3_f32 v193, v193, v205, v12
    v_min3_f32 v194, v194, v206, v12
    v_min3_f32 v195, v195, v207, v12
    v_cndmask_b32 v12, v12, v192, vcc
    v_cmp_eq_u32 vcc, 1, v14
    v_exp_f32 v45, v45
    v_exp_f32 v46, v46
    v_cndmask_b32 v12, v12, v193, vcc
    v_cmp_eq_u32 vcc, 2, v14
    v_exp_f32 v47, v47
    v_cvt_pk_bf16_f32 v58, v44, v45
    v_cndmask_b32 v12, v12, v194, vcc
    v_cmp_eq_u32 vcc, 3, v14
    v_cvt_pk_bf16_f32 v59, v46, v47
    v_exp_f32 v48, v48
    v_cndmask_b32 v12, v12, v195, vcc
    v_mov_b32 v13, v12
    v_exp_f32 v49, v49
    v_exp_f32 v50, v50
    v_permlane32_swap_b32 v12, v13
    v_min_f32 v12, v12, v13
    v_mov_b32 v13, v12
    v_exp_f32 v51, v51
    v_exp_f32 v52, v52
    v_permlane16_swap_b32 v12, v13
    v_min_f32 v12, v12, v13
    v_exp_f32 v53, v53
    v_exp_f32 v54, v54
    v_min_f32_dpp v12, v12, v12 row_ror:8 row_mask:0xf bank_mask:0xf
    v_exp_f32 v55, v55
    v_cvt_pk_bf16_f32 v60, v48, v49
    v_min_f32_dpp v12, v12, v12 row_ror:4 row_mask:0xf bank_mask:0xf
    v_cvt_pk_bf16_f32 v61, v50, v51
    v_cvt_pk_bf16_f32 v62, v52, v53
    v_min_f32_dpp v12, v12, v12 row_ror:2 row_mask:0xf bank_mask:0xf
    v_cvt_pk_bf16_f32 v63, v54, v55
    v_add_u32 v236, 0x18000, v236
    v_min_f32_dpp v12, v12, v12 row_ror:1 row_mask:0xf bank_mask:0xf
    v_mul_f32 v12, 0x39000000, v12
    v_sqrt_f32 v12, v12
    v_add_u32 v237, 0x18000, v237
    v_and_b32 v12, 0x7f800000, v12
    v_mul_f32 v12, s34, v12
    v_mov_b32 v13, v12
    v_mov_b32 v14, v12
    v_mov_b32 v15, v12
    v_add_u32 v238, 0x18000, v238
    v_add_u32 v239, 0x18000, v239
    v_mfma_f32_16x16x32_bf16 v[64:67], a[160:163], v[56:59], v[12:15]
    v_readfirstlane_b32 s34, v12
    v_mfma_f32_16x16x32_bf16 v[68:71], a[164:167], v[56:59], v[12:15]
    v_mfma_f32_16x16x32_bf16 v[72:75], a[168:171], v[56:59], v[12:15]
    v_mfma_f32_16x16x32_bf16 v[76:79], a[172:175], v[56:59], v[12:15]
    v_mfma_f32_16x16x32_bf16 v[80:83], a[176:179], v[56:59], v[12:15]
    v_mfma_f32_16x16x32_bf16 v[84:87], a[180:183], v[56:59], v[12:15]
    v_mfma_f32_16x16x32_bf16 v[88:91], a[184:187], v[56:59], v[12:15]
    v_mfma_f32_16x16x32_bf16 v[92:95], a[188:191], v[56:59], v[12:15]
    v_mfma_f32_16x16x32_bf16 a[224:227], a[248:251], v[56:59], 0
    s_waitcnt lgkmcnt(0)
    v_mfma_f32_16x16x32_bf16 v[240:243], v[226:229], a[16:19], 0
    v_mfma_f32_16x16x32_bf16 v[240:243], v[230:233], a[16:19], v[240:243]
    v_mfma_f32_16x16x32_bf16 v[244:247], v[224:227], a[16:19], 0
    v_mfma_f32_16x16x32_bf16 v[244:247], v[228:231], a[16:19], v[244:247]
    v_mfma_f32_16x16x32_bf16 v[248:251], v[226:229], a[20:23], 0
    v_mfma_f32_16x16x32_bf16 v[248:251], v[230:233], a[20:23], v[248:251]
    v_mfma_f32_16x16x32_bf16 v[252:255], v[224:227], a[20:23], 0
    v_mfma_f32_16x16x32_bf16 v[252:255], v[228:231], a[20:23], v[252:255]
    s_nop 1
    v_cvt_pk_bf16_f32 v240, v240, v241
    v_cvt_pk_bf16_f32 v242, v242, v243
    v_accvgpr_write_b32 a16, v240
    v_accvgpr_write_b32 a17, v242
    v_mfma_f32_16x16x32_bf16 v[240:243], v[226:229], a[24:27], 0
    v_cvt_pk_bf16_f32 v244, v244, v245
    v_cvt_pk_bf16_f32 v246, v246, v247
    v_mfma_f32_16x16x32_bf16 v[240:243], v[230:233], a[24:27], v[240:243]
    v_accvgpr_write_b32 a18, v244
    v_accvgpr_write_b32 a19, v246
    v_mfma_f32_16x16x32_bf16 v[244:247], v[224:227], a[24:27], 0
    v_cvt_pk_bf16_f32 v248, v248, v249
    v_cvt_pk_bf16_f32 v250, v250, v251
    v_mfma_f32_16x16x32_bf16 v[244:247], v[228:231], a[24:27], v[244:247]
    v_accvgpr_write_b32 a20, v248
    v_accvgpr_write_b32 a21, v250
    v_mfma_f32_16x16x32_bf16 v[248:251], v[226:229], a[28:31], 0
    v_cvt_pk_bf16_f32 v252, v252, v253
    v_cvt_pk_bf16_f32 v254, v254, v255
    v_mfma_f32_16x16x32_bf16 v[248:251], v[230:233], a[28:31], v[248:251]
    v_accvgpr_write_b32 a22, v252
    v_accvgpr_write_b32 a23, v254
    v_mfma_f32_16x16x32_bf16 v[252:255], v[224:227], a[28:31], 0
    v_cvt_pk_bf16_f32 v240, v240, v241
    v_cvt_pk_bf16_f32 v242, v242, v243
    v_mfma_f32_16x16x32_bf16 v[252:255], v[228:231], a[28:31], v[252:255]
    v_cvt_pk_bf16_f32 v244, v244, v245
    v_cvt_pk_bf16_f32 v246, v246, v247
    v_mfma_f32_16x16x32_bf16 v[40:43], a[96:99], a[16:19], 0
    v_accvgpr_write_b32 a24, v240
    v_accvgpr_write_b32 a25, v242
    v_mfma_f32_16x16x32_bf16 v[40:43], a[100:103], a[20:23], v[40:43]
    v_accvgpr_write_b32 a26, v244
    v_accvgpr_write_b32 a27, v246
    v_cvt_pk_bf16_f32 v248, v248, v249
    v_cvt_pk_bf16_f32 v250, v250, v251
    v_mfma_f32_16x16x32_bf16 v[40:43], a[104:107], a[24:27], v[40:43]
    v_cvt_pk_bf16_f32 v252, v252, v253
    v_cvt_pk_bf16_f32 v254, v254, v255
    v_accvgpr_write_b32 a28, v248
    v_accvgpr_write_b32 a29, v250
    v_accvgpr_write_b32 a30, v252
    v_accvgpr_write_b32 a31, v254
    s_nop 1
    v_mfma_f32_16x16x32_bf16 v[40:43], a[108:111], a[28:31], v[40:43]
    v_mfma_f32_16x16x32_bf16 v[44:47], a[112:115], a[16:19], 0
    v_mfma_f32_16x16x32_bf16 v[44:47], a[116:119], a[20:23], v[44:47]
    v_mfma_f32_16x16x32_bf16 v[44:47], a[120:123], a[24:27], v[44:47]
    v_mfma_f32_16x16x32_bf16 v[44:47], a[124:127], a[28:31], v[44:47]
    s_waitcnt vmcnt(8)
    ds_read_b128 a[32:35], v236 offset:0
    v_mfma_f32_16x16x32_bf16 v[64:67], a[192:195], v[60:63], v[64:67]
    ds_read_b128 a[36:39], v237 offset:0
    v_max3_f32 v0, v40, v41, v42
    v_mfma_f32_16x16x32_bf16 v[68:71], a[196:199], v[60:63], v[68:71]
    ds_read_b128 a[40:43], v238 offset:0
    ds_read_b128 a[44:47], v239 offset:0
    v_mfma_f32_16x16x32_bf16 v[72:75], a[200:203], v[60:63], v[72:75]
    buffer_load_dwordx4 v3, s[4:7], s29 offen offset:0 nt lds
    v_mfma_f32_16x16x32_bf16 v[76:79], a[204:207], v[60:63], v[76:79]
    buffer_load_dwordx4 v234, s[4:7], s29 offen offset:1024 nt lds
    v_mfma_f32_16x16x32_bf16 v[80:83], a[208:211], v[60:63], v[80:83]
    buffer_load_dwordx4 v3, s[4:7], s29 offen offset:2048 nt lds
    v_mfma_f32_16x16x32_bf16 v[84:87], a[212:215], v[60:63], v[84:87]
    buffer_load_dwordx4 v234, s[4:7], s29 offen offset:3072 nt lds
    v_mfma_f32_16x16x32_bf16 v[88:91], a[216:219], v[60:63], v[88:91]
    s_add_u32 s29, s29, 4096
    v_max3_f32 v1, v43, v44, v45
    v_max3_f32 v0, v0, v46, v47
    v_mfma_f32_16x16x32_bf16 v[92:95], a[220:223], v[60:63], v[92:95]
    s_and_b32 m0, s21, 0xffff
    v_max_f32 v0, v0, v1
    v_mov_b32 v1, v0
    v_mfma_f32_16x16x32_bf16 a[224:227], a[248:251], v[60:63], a[224:227]
    s_nop 0
    v_permlane32_swap_b32 v0, v1
    s_waitcnt lgkmcnt(2)
    v_mfma_f32_16x16x32_bf16 v[240:243], v[226:229], a[32:35], 0
    v_max_f32 v0, v0, v1
    v_mov_b32 v1, v0
    v_mfma_f32_16x16x32_bf16 v[240:243], v[230:233], a[32:35], v[240:243]
    s_nop 0
    v_permlane16_swap_b32 v0, v1
    v_mfma_f32_16x16x32_bf16 v[244:247], v[224:227], a[32:35], 0
    v_max_f32 v0, v0, v1
    v_min_f32 v20, -v0, v20
    v_mfma_f32_16x16x32_bf16 v[244:247], v[228:231], a[32:35], v[244:247]
    v_add_f32 v20, 0xc1300000, v20
    v_mov_b32 v21, v20
    v_mov_b32 v22, v20
    v_mov_b32 v23, v20
    v_cvt_pk_bf16_f32 v240, v240, v241
    v_cvt_pk_bf16_f32 v242, v242, v243
    v_mfma_f32_16x16x32_bf16 v[48:51], a[128:131], a[16:19], v[20:23]
    v_accvgpr_write_b32 a32, v240
    v_accvgpr_write_b32 a33, v242
    v_mfma_f32_16x16x32_bf16 v[48:51], a[132:135], a[20:23], v[48:51]
    v_cvt_pk_bf16_f32 v244, v244, v245
    v_cvt_pk_bf16_f32 v246, v246, v247
    v_mfma_f32_16x16x32_bf16 v[48:51], a[136:139], a[24:27], v[48:51]
    v_accvgpr_write_b32 a34, v244
    v_accvgpr_write_b32 a35, v246
    v_mfma_f32_16x16x32_bf16 v[48:51], a[140:143], a[28:31], v[48:51]
    v_add_f32 v40, v40, v20
    v_add_f32 v41, v41, v20
    v_mfma_f32_16x16x32_bf16 v[52:55], a[144:147], a[16:19], v[20:23]
    v_add_f32 v42, v42, v20
    v_add_f32 v43, v43, v20
    v_mfma_f32_16x16x32_bf16 v[52:55], a[148:151], a[20:23], v[52:55]
    v_add_f32 v44, v44, v20
    v_add_f32 v45, v45, v20
    v_mfma_f32_16x16x32_bf16 v[52:55], a[152:155], a[24:27], v[52:55]
    v_add_f32 v46, v46, v20
    v_add_f32 v47, v47, v20
    v_mfma_f32_16x16x32_bf16 v[52:55], a[156:159], a[28:31], v[52:55]
    v_exp_f32 v40, v40
    v_mfma_f32_16x16x32_bf16 v[248:251], v[226:229], a[36:39], 0
    v_exp_f32 v41, v41
    v_mfma_f32_16x16x32_bf16 v[248:251], v[230:233], a[36:39], v[248:251]
    v_exp_f32 v42, v42
    v_mfma_f32_16x16x32_bf16 v[252:255], v[224:227], a[36:39], 0
    v_exp_f32 v43, v43
    v_mfma_f32_16x16x32_bf16 v[252:255], v[228:231], a[36:39], v[252:255]
    v_exp_f32 v44, v44
    s_waitcnt lgkmcnt(0)
    v_mfma_f32_16x16x32_bf16 v[240:243], v[226:229], a[40:43], 0
    v_exp_f32 v45, v45
    v_mfma_f32_16x16x32_bf16 v[240:243], v[230:233], a[40:43], v[240:243]
    v_cvt_pk_bf16_f32 v248, v248, v249
    v_cvt_pk_bf16_f32 v250, v250, v251
    v_mfma_f32_16x16x32_bf16 v[244:247], v[224:227], a[40:43], 0
    v_accvgpr_write_b32 a36, v248
    v_accvgpr_write_b32 a37, v250
    v_mfma_f32_16x16x32_bf16 v[244:247], v[228:231], a[40:43], v[244:247]
    v_cvt_pk_bf16_f32 v252, v252, v253
    v_cvt_pk_bf16_f32 v254, v254, v255
    v_mfma_f32_16x16x32_bf16 v[248:251], v[226:229], a[44:47], 0
    v_accvgpr_write_b32 a38, v252
    v_accvgpr_write_b32 a39, v254
    v_mfma_f32_16x16x32_bf16 v[248:251], v[230:233], a[44:47], v[248:251]
    v_exp_f32 v46, v46
    v_mfma_f32_16x16x32_bf16 v[252:255], v[224:227], a[44:47], 0
    v_exp_f32 v47, v47
    v_mfma_f32_16x16x32_bf16 v[252:255], v[228:231], a[44:47], v[252:255]
    v_cvt_pk_bf16_f32 v56, v40, v41
    v_cvt_pk_bf16_f32 v57, v42, v43
    v_cvt_pk_bf16_f32 v58, v44, v45
    v_cvt_pk_bf16_f32 v59, v46, v47
    v_cvt_pk_bf16_f32 v240, v240, v241
    v_cvt_pk_bf16_f32 v242, v242, v243
    v_mfma_f32_16x16x32_bf16 v[96:99], a[160:163], v[56:59], v[12:15]
    v_cvt_pk_bf16_f32 v244, v244, v245
    v_cvt_pk_bf16_f32 v246, v246, v247
    v_mfma_f32_16x16x32_bf16 v[100:103], a[164:167], v[56:59], v[12:15]
    v_accvgpr_write_b32 a40, v240
    v_accvgpr_write_b32 a41, v242
    v_mfma_f32_16x16x32_bf16 v[104:107], a[168:171], v[56:59], v[12:15]
    v_accvgpr_write_b32 a42, v244
    v_accvgpr_write_b32 a43, v246
    v_mfma_f32_16x16x32_bf16 v[108:111], a[172:175], v[56:59], v[12:15]
    v_cvt_pk_bf16_f32 v248, v248, v249
    v_cvt_pk_bf16_f32 v250, v250, v251
    v_mfma_f32_16x16x32_bf16 v[112:115], a[176:179], v[56:59], v[12:15]
    v_cvt_pk_bf16_f32 v252, v252, v253
    v_cvt_pk_bf16_f32 v254, v254, v255
    v_mfma_f32_16x16x32_bf16 v[116:119], a[180:183], v[56:59], v[12:15]
    v_accvgpr_write_b32 a44, v248
    v_accvgpr_write_b32 a45, v250
    v_mfma_f32_16x16x32_bf16 v[120:123], a[184:187], v[56:59], v[12:15]
    v_accvgpr_write_b32 a46, v252
    v_accvgpr_write_b32 a47, v254
    v_mfma_f32_16x16x32_bf16 v[124:127], a[188:191], v[56:59], v[12:15]
    v_exp_f32 v48, v48
    v_mfma_f32_16x16x32_bf16 a[228:231], a[248:251], v[56:59], 0
    v_exp_f32 v49, v49
    v_mfma_f32_16x16x32_bf16 v[40:43], a[96:99], a[32:35], 0
    v_exp_f32 v50, v50
    v_mfma_f32_16x16x32_bf16 v[40:43], a[100:103], a[36:39], v[40:43]
    v_exp_f32 v51, v51
    v_mfma_f32_16x16x32_bf16 v[40:43], a[104:107], a[40:43], v[40:43]
    v_exp_f32 v52, v52
    v_mfma_f32_16x16x32_bf16 v[40:43], a[108:111], a[44:47], v[40:43]
    v_exp_f32 v53, v53
    v_mfma_f32_16x16x32_bf16 v[44:47], a[112:115], a[32:35], 0
    v_exp_f32 v54, v54
    v_mfma_f32_16x16x32_bf16 v[44:47], a[116:119], a[36:39], v[44:47]
    v_exp_f32 v55, v55
    v_mfma_f32_16x16x32_bf16 v[44:47], a[120:123], a[40:43], v[44:47]
    v_cvt_pk_bf16_f32 v60, v48, v49
    v_cvt_pk_bf16_f32 v61, v50, v51
    v_mfma_f32_16x16x32_bf16 v[44:47], a[124:127], a[44:47], v[44:47]
    s_waitcnt vmcnt(8)
    ds_read_b128 a[48:51], v236 offset:16384
    ds_read_b128 a[52:55], v237 offset:16384
    ds_read_b128 a[56:59], v238 offset:16384
    ds_read_b128 a[60:63], v239 offset:16384
    buffer_load_dwordx4 v3, s[8:11], s21 offen nt lds
    buffer_load_dwordx4 v3, s[8:11], s21 offen offset:2048 nt lds
    s_bitset1_b32 m0, 16
    v_cvt_pk_bf16_f32 v62, v52, v53
    buffer_load_dwordx4 v3, s[12:15], s21 offen nt lds
    buffer_load_dwordx4 v3, s[12:15], s21 offen offset:2048 nt lds
    s_add_u32 s21, s21, 8192
    s_and_b32 m0, s21, 0xffff
    v_cvt_pk_bf16_f32 v63, v54, v55
    v_max3_f32 v0, v40, v41, v42
    v_max3_f32 v1, v43, v44, v45
    v_mfma_f32_16x16x32_bf16 v[96:99], a[192:195], v[60:63], v[96:99]
    v_max3_f32 v0, v0, v46, v47
    v_max_f32 v0, v0, v1
    v_mfma_f32_16x16x32_bf16 v[100:103], a[196:199], v[60:63], v[100:103]
    v_mov_b32 v1, v0
    v_mfma_f32_16x16x32_bf16 v[104:107], a[200:203], v[60:63], v[104:107]
    s_nop 0
    v_permlane32_swap_b32 v0, v1
    v_mfma_f32_16x16x32_bf16 v[108:111], a[204:207], v[60:63], v[108:111]
    v_max_f32 v0, v0, v1
    v_mov_b32 v1, v0
    v_mfma_f32_16x16x32_bf16 v[112:115], a[208:211], v[60:63], v[112:115]
    s_nop 0
    v_permlane16_swap_b32 v0, v1
    v_mfma_f32_16x16x32_bf16 v[116:119], a[212:215], v[60:63], v[116:119]
    v_max_f32 v0, v0, v1
    v_min_f32 v24, -v0, v24
    v_mfma_f32_16x16x32_bf16 v[120:123], a[216:219], v[60:63], v[120:123]
    v_add_f32 v24, 0xc1300000, v24
    v_mov_b32 v25, v24
    v_mfma_f32_16x16x32_bf16 v[124:127], a[220:223], v[60:63], v[124:127]
    v_mov_b32 v26, v24
    v_mov_b32 v27, v24
    v_mfma_f32_16x16x32_bf16 a[228:231], a[248:251], v[60:63], a[228:231]
    v_add_f32 v40, v40, v24
    v_add_f32 v41, v41, v24
    s_waitcnt lgkmcnt(0)
    v_mfma_f32_16x16x32_bf16 v[240:243], v[226:229], a[48:51], 0
    v_add_f32 v42, v42, v24
    v_add_f32 v43, v43, v24
    v_mfma_f32_16x16x32_bf16 v[240:243], v[230:233], a[48:51], v[240:243]
    v_add_f32 v44, v44, v24
    v_add_f32 v45, v45, v24
    v_mfma_f32_16x16x32_bf16 v[244:247], v[224:227], a[48:51], 0
    v_add_f32 v46, v46, v24
    v_add_f32 v47, v47, v24
    v_mfma_f32_16x16x32_bf16 v[244:247], v[228:231], a[48:51], v[244:247]
    v_exp_f32 v40, v40
    v_mfma_f32_16x16x32_bf16 v[48:51], a[128:131], a[32:35], v[24:27]
    v_cvt_pk_bf16_f32 v240, v240, v241
    v_cvt_pk_bf16_f32 v242, v242, v243
    v_mfma_f32_16x16x32_bf16 v[48:51], a[132:135], a[36:39], v[48:51]
    v_accvgpr_write_b32 a48, v240
    v_accvgpr_write_b32 a49, v242
    v_mfma_f32_16x16x32_bf16 v[48:51], a[136:139], a[40:43], v[48:51]
    v_cvt_pk_bf16_f32 v244, v244, v245
    v_cvt_pk_bf16_f32 v246, v246, v247
    v_mfma_f32_16x16x32_bf16 v[48:51], a[140:143], a[44:47], v[48:51]
    v_accvgpr_write_b32 a50, v244
    v_accvgpr_write_b32 a51, v246
    v_mfma_f32_16x16x32_bf16 v[52:55], a[144:147], a[32:35], v[24:27]
    v_exp_f32 v41, v41
    v_mfma_f32_16x16x32_bf16 v[52:55], a[148:151], a[36:39], v[52:55]
    v_exp_f32 v42, v42
    v_mfma_f32_16x16x32_bf16 v[52:55], a[152:155], a[40:43], v[52:55]
    v_exp_f32 v43, v43
    v_mfma_f32_16x16x32_bf16 v[52:55], a[156:159], a[44:47], v[52:55]
    v_exp_f32 v44, v44
    v_mfma_f32_16x16x32_bf16 v[248:251], v[226:229], a[52:55], 0
    v_exp_f32 v45, v45
    v_mfma_f32_16x16x32_bf16 v[248:251], v[230:233], a[52:55], v[248:251]
    v_exp_f32 v46, v46
    v_mfma_f32_16x16x32_bf16 v[252:255], v[224:227], a[52:55], 0
    v_exp_f32 v47, v47
    v_mfma_f32_16x16x32_bf16 v[252:255], v[228:231], a[52:55], v[252:255]
    v_cvt_pk_bf16_f32 v56, v40, v41
    v_cvt_pk_bf16_f32 v57, v42, v43
    v_mfma_f32_16x16x32_bf16 v[240:243], v[226:229], a[56:59], 0
    v_cvt_pk_bf16_f32 v58, v44, v45
    v_cvt_pk_bf16_f32 v248, v248, v249
    v_mfma_f32_16x16x32_bf16 v[240:243], v[230:233], a[56:59], v[240:243]
    v_cvt_pk_bf16_f32 v250, v250, v251
    v_accvgpr_write_b32 a52, v248
    v_mfma_f32_16x16x32_bf16 v[244:247], v[224:227], a[56:59], 0
    v_accvgpr_write_b32 a53, v250
    v_cvt_pk_bf16_f32 v252, v252, v253
    v_mfma_f32_16x16x32_bf16 v[244:247], v[228:231], a[56:59], v[244:247]
    v_cvt_pk_bf16_f32 v254, v254, v255
    v_accvgpr_write_b32 a54, v252
    v_mfma_f32_16x16x32_bf16 v[248:251], v[226:229], a[60:63], 0
    v_accvgpr_write_b32 a55, v254
    v_cvt_pk_bf16_f32 v59, v46, v47
    v_mfma_f32_16x16x32_bf16 v[248:251], v[230:233], a[60:63], v[248:251]
    v_cvt_pk_bf16_f32 v240, v240, v241
    v_cvt_pk_bf16_f32 v242, v242, v243
    v_mfma_f32_16x16x32_bf16 v[252:255], v[224:227], a[60:63], 0
    v_cvt_pk_bf16_f32 v244, v244, v245
    v_cvt_pk_bf16_f32 v246, v246, v247
    v_mfma_f32_16x16x32_bf16 v[252:255], v[228:231], a[60:63], v[252:255]
    v_accvgpr_write_b32 a56, v240
    v_accvgpr_write_b32 a57, v242
    v_mfma_f32_16x16x32_bf16 v[128:131], a[160:163], v[56:59], v[12:15]
    v_accvgpr_write_b32 a58, v244
    v_accvgpr_write_b32 a59, v246
    v_mfma_f32_16x16x32_bf16 v[132:135], a[164:167], v[56:59], v[12:15]
    v_cvt_pk_bf16_f32 v248, v248, v249
    v_cvt_pk_bf16_f32 v250, v250, v251
    v_mfma_f32_16x16x32_bf16 v[136:139], a[168:171], v[56:59], v[12:15]
    v_cvt_pk_bf16_f32 v252, v252, v253
    v_cvt_pk_bf16_f32 v254, v254, v255
    v_mfma_f32_16x16x32_bf16 v[140:143], a[172:175], v[56:59], v[12:15]
    v_accvgpr_write_b32 a60, v248
    v_accvgpr_write_b32 a61, v250
    v_mfma_f32_16x16x32_bf16 v[144:147], a[176:179], v[56:59], v[12:15]
    v_accvgpr_write_b32 a62, v252
    v_accvgpr_write_b32 a63, v254
    v_mfma_f32_16x16x32_bf16 v[148:151], a[180:183], v[56:59], v[12:15]
    v_exp_f32 v48, v48
    v_mfma_f32_16x16x32_bf16 v[152:155], a[184:187], v[56:59], v[12:15]
    v_exp_f32 v49, v49
    v_mfma_f32_16x16x32_bf16 v[156:159], a[188:191], v[56:59], v[12:15]
    v_exp_f32 v50, v50
    v_mfma_f32_16x16x32_bf16 a[232:235], a[248:251], v[56:59], 0
    v_exp_f32 v51, v51
    v_mfma_f32_16x16x32_bf16 v[40:43], a[96:99], a[48:51], 0
    v_exp_f32 v52, v52
    v_mfma_f32_16x16x32_bf16 v[40:43], a[100:103], a[52:55], v[40:43]
    v_exp_f32 v53, v53
    v_mfma_f32_16x16x32_bf16 v[40:43], a[104:107], a[56:59], v[40:43]
    v_exp_f32 v54, v54
    v_mfma_f32_16x16x32_bf16 v[40:43], a[108:111], a[60:63], v[40:43]
    v_exp_f32 v55, v55
    v_mfma_f32_16x16x32_bf16 v[44:47], a[112:115], a[48:51], 0
    v_cvt_pk_bf16_f32 v60, v48, v49
    v_cvt_pk_bf16_f32 v61, v50, v51
    v_mfma_f32_16x16x32_bf16 v[44:47], a[116:119], a[52:55], v[44:47]
    v_cvt_pk_bf16_f32 v62, v52, v53
    v_cvt_pk_bf16_f32 v63, v54, v55
    v_mfma_f32_16x16x32_bf16 v[44:47], a[120:123], a[56:59], v[44:47]
    v_max3_f32 v0, v40, v41, v42
    v_mfma_f32_16x16x32_bf16 v[44:47], a[124:127], a[60:63], v[44:47]
    s_waitcnt vmcnt(8)
    ds_read_b128 a[64:67], v236 offset:32768
    v_mfma_f32_16x16x32_bf16 v[128:131], a[192:195], v[60:63], v[128:131]
    ds_read_b128 a[68:71], v237 offset:32768
    ds_read_b128 a[72:75], v238 offset:32768
    v_mfma_f32_16x16x32_bf16 v[132:135], a[196:199], v[60:63], v[132:135]
    ds_read_b128 a[76:79], v239 offset:32768
    buffer_load_dwordx4 v3, s[8:11], s21 offen nt lds
    v_mfma_f32_16x16x32_bf16 v[136:139], a[200:203], v[60:63], v[136:139]
    buffer_load_dwordx4 v3, s[8:11], s21 offen offset:2048 nt lds
    v_mfma_f32_16x16x32_bf16 v[140:143], a[204:207], v[60:63], v[140:143]
    s_bitset1_b32 m0, 16
    v_max3_f32 v1, v43, v44, v45
    v_max3_f32 v0, v0, v46, v47
    v_mfma_f32_16x16x32_bf16 v[144:147], a[208:211], v[60:63], v[144:147]
    buffer_load_dwordx4 v3, s[12:15], s21 offen nt lds
    v_mfma_f32_16x16x32_bf16 v[148:151], a[212:215], v[60:63], v[148:151]
    buffer_load_dwordx4 v3, s[12:15], s21 offen offset:2048 nt lds
    v_mfma_f32_16x16x32_bf16 v[152:155], a[216:219], v[60:63], v[152:155]
    s_add_u32 s21, s21, 8192
    v_max_f32 v0, v0, v1
    v_mov_b32 v1, v0
    v_mfma_f32_16x16x32_bf16 v[156:159], a[220:223], v[60:63], v[156:159]
    s_nop 0
    v_permlane32_swap_b32 v0, v1
    v_mfma_f32_16x16x32_bf16 a[232:235], a[248:251], v[60:63], a[232:235]
    v_max_f32 v0, v0, v1
    v_mov_b32 v1, v0
    s_waitcnt lgkmcnt(1)
    v_mfma_f32_16x16x32_bf16 v[240:243], v[226:229], a[64:67], 0
    v_permlane16_swap_b32 v0, v1
    v_mfma_f32_16x16x32_bf16 v[240:243], v[230:233], a[64:67], v[240:243]
    v_max_f32 v0, v0, v1
    v_min_f32 v28, -v0, v28
    v_mfma_f32_16x16x32_bf16 v[244:247], v[224:227], a[64:67], 0
    v_add_f32 v28, 0xc1300000, v28
    v_mov_b32 v29, v28
    v_mfma_f32_16x16x32_bf16 v[244:247], v[228:231], a[64:67], v[244:247]
    v_mov_b32 v30, v28
    v_mov_b32 v31, v28
    v_cvt_pk_bf16_f32 v240, v240, v241
    v_cvt_pk_bf16_f32 v242, v242, v243
    v_mfma_f32_16x16x32_bf16 v[48:51], a[128:131], a[48:51], v[28:31]
    v_accvgpr_write_b32 a64, v240
    v_accvgpr_write_b32 a65, v242
    v_mfma_f32_16x16x32_bf16 v[48:51], a[132:135], a[52:55], v[48:51]
    v_cvt_pk_bf16_f32 v244, v244, v245
    v_cvt_pk_bf16_f32 v246, v246, v247
    v_mfma_f32_16x16x32_bf16 v[48:51], a[136:139], a[56:59], v[48:51]
    v_accvgpr_write_b32 a66, v244
    v_accvgpr_write_b32 a67, v246
    v_mfma_f32_16x16x32_bf16 v[48:51], a[140:143], a[60:63], v[48:51]
    v_add_f32 v40, v40, v28
    v_add_f32 v41, v41, v28
    v_mfma_f32_16x16x32_bf16 v[52:55], a[144:147], a[48:51], v[28:31]
    v_add_f32 v42, v42, v28
    v_add_f32 v43, v43, v28
    v_mfma_f32_16x16x32_bf16 v[52:55], a[148:151], a[52:55], v[52:55]
    v_add_f32 v44, v44, v28
    v_add_f32 v45, v45, v28
    v_mfma_f32_16x16x32_bf16 v[52:55], a[152:155], a[56:59], v[52:55]
    v_add_f32 v46, v46, v28
    v_add_f32 v47, v47, v28
    v_mfma_f32_16x16x32_bf16 v[52:55], a[156:159], a[60:63], v[52:55]
    v_exp_f32 v40, v40
    v_mfma_f32_16x16x32_bf16 v[248:251], v[226:229], a[68:71], 0
    v_exp_f32 v41, v41
    v_mfma_f32_16x16x32_bf16 v[248:251], v[230:233], a[68:71], v[248:251]
    v_exp_f32 v42, v42
    v_mfma_f32_16x16x32_bf16 v[252:255], v[224:227], a[68:71], 0
    v_exp_f32 v43, v43
    v_mfma_f32_16x16x32_bf16 v[252:255], v[228:231], a[68:71], v[252:255]
    v_exp_f32 v44, v44
    v_mfma_f32_16x16x32_bf16 v[240:243], v[226:229], a[72:75], 0
    v_exp_f32 v45, v45
    v_mfma_f32_16x16x32_bf16 v[240:243], v[230:233], a[72:75], v[240:243]
    v_cvt_pk_bf16_f32 v248, v248, v249
    v_cvt_pk_bf16_f32 v250, v250, v251
    v_mfma_f32_16x16x32_bf16 v[244:247], v[224:227], a[72:75], 0
    v_accvgpr_write_b32 a68, v248
    v_accvgpr_write_b32 a69, v250
    v_mfma_f32_16x16x32_bf16 v[244:247], v[228:231], a[72:75], v[244:247]
    v_cvt_pk_bf16_f32 v252, v252, v253
    v_cvt_pk_bf16_f32 v254, v254, v255
    s_waitcnt lgkmcnt(0)
    v_mfma_f32_16x16x32_bf16 v[248:251], v[226:229], a[76:79], 0
    v_accvgpr_write_b32 a70, v252
    v_accvgpr_write_b32 a71, v254
    v_mfma_f32_16x16x32_bf16 v[248:251], v[230:233], a[76:79], v[248:251]
    v_exp_f32 v46, v46
    v_mfma_f32_16x16x32_bf16 v[252:255], v[224:227], a[76:79], 0
    v_exp_f32 v47, v47
    v_mfma_f32_16x16x32_bf16 v[252:255], v[228:231], a[76:79], v[252:255]
    v_cvt_pk_bf16_f32 v56, v40, v41
    v_cvt_pk_bf16_f32 v57, v42, v43
    v_cvt_pk_bf16_f32 v58, v44, v45
    v_cvt_pk_bf16_f32 v59, v46, v47
    v_cvt_pk_bf16_f32 v240, v240, v241
    v_cvt_pk_bf16_f32 v242, v242, v243
    v_mfma_f32_16x16x32_bf16 v[160:163], a[160:163], v[56:59], v[12:15]
    v_cvt_pk_bf16_f32 v244, v244, v245
    v_cvt_pk_bf16_f32 v246, v246, v247
    v_mfma_f32_16x16x32_bf16 v[164:167], a[164:167], v[56:59], v[12:15]
    v_accvgpr_write_b32 a72, v240
    v_accvgpr_write_b32 a73, v242
    v_mfma_f32_16x16x32_bf16 v[168:171], a[168:171], v[56:59], v[12:15]
    v_accvgpr_write_b32 a74, v244
    v_accvgpr_write_b32 a75, v246
    v_mfma_f32_16x16x32_bf16 v[172:175], a[172:175], v[56:59], v[12:15]
    v_cvt_pk_bf16_f32 v248, v248, v249
    v_cvt_pk_bf16_f32 v250, v250, v251
    v_mfma_f32_16x16x32_bf16 v[176:179], a[176:179], v[56:59], v[12:15]
    v_cvt_pk_bf16_f32 v252, v252, v253
    v_cvt_pk_bf16_f32 v254, v254, v255
    v_mfma_f32_16x16x32_bf16 v[180:183], a[180:183], v[56:59], v[12:15]
    v_accvgpr_write_b32 a76, v248
    v_accvgpr_write_b32 a77, v250
    v_mfma_f32_16x16x32_bf16 v[184:187], a[184:187], v[56:59], v[12:15]
    v_accvgpr_write_b32 a78, v252
    v_accvgpr_write_b32 a79, v254
    v_mfma_f32_16x16x32_bf16 v[188:191], a[188:191], v[56:59], v[12:15]
    v_exp_f32 v48, v48
    v_mfma_f32_16x16x32_bf16 a[236:239], a[248:251], v[56:59], 0
    v_exp_f32 v49, v49
    v_mfma_f32_16x16x32_bf16 v[40:43], a[96:99], a[64:67], 0
    v_exp_f32 v50, v50
    v_mfma_f32_16x16x32_bf16 v[40:43], a[100:103], a[68:71], v[40:43]
    v_exp_f32 v51, v51
    v_mfma_f32_16x16x32_bf16 v[40:43], a[104:107], a[72:75], v[40:43]
    v_exp_f32 v52, v52
    v_mfma_f32_16x16x32_bf16 v[40:43], a[108:111], a[76:79], v[40:43]
    v_exp_f32 v53, v53
    v_mfma_f32_16x16x32_bf16 v[44:47], a[112:115], a[64:67], 0
    v_exp_f32 v54, v54
    v_mfma_f32_16x16x32_bf16 v[44:47], a[116:119], a[68:71], v[44:47]
    v_exp_f32 v55, v55
    v_mfma_f32_16x16x32_bf16 v[44:47], a[120:123], a[72:75], v[44:47]
    v_cvt_pk_bf16_f32 v60, v48, v49
    v_cvt_pk_bf16_f32 v61, v50, v51
    v_mfma_f32_16x16x32_bf16 v[44:47], a[124:127], a[76:79], v[44:47]
    s_waitcnt vmcnt(8)
    v_cvt_pk_bf16_f32 v62, v52, v53
    v_cvt_pk_bf16_f32 v63, v54, v55
    v_max3_f32 v0, v40, v41, v42
    ds_read_b128 a[80:83], v236 offset:49152
    v_mfma_f32_16x16x32_bf16 v[160:163], a[192:195], v[60:63], v[160:163]
    ds_read_b128 a[84:87], v237 offset:49152
    v_mfma_f32_16x16x32_bf16 v[164:167], a[196:199], v[60:63], v[164:167]
    ds_read_b128 a[88:91], v238 offset:49152
    v_max3_f32 v1, v43, v44, v45
    v_mfma_f32_16x16x32_bf16 v[168:171], a[200:203], v[60:63], v[168:171]
    ds_read_b128 a[92:95], v239 offset:49152
    v_max3_f32 v0, v0, v46, v47
    v_mfma_f32_16x16x32_bf16 v[172:175], a[204:207], v[60:63], v[172:175]
    v_max_f32 v0, v0, v1
    v_mov_b32 v1, v0
    v_mfma_f32_16x16x32_bf16 v[176:179], a[208:211], v[60:63], v[176:179]
    s_nop 0
    v_permlane32_swap_b32 v0, v1
    v_mfma_f32_16x16x32_bf16 v[180:183], a[212:215], v[60:63], v[180:183]
    v_max_f32 v0, v0, v1
    v_mov_b32 v1, v0
    v_mfma_f32_16x16x32_bf16 v[184:187], a[216:219], v[60:63], v[184:187]
    s_nop 0
    v_permlane16_swap_b32 v0, v1
    v_mfma_f32_16x16x32_bf16 v[188:191], a[220:223], v[60:63], v[188:191]
    v_max_f32 v0, v0, v1
    v_min_f32 v32, -v0, v32
    v_mfma_f32_16x16x32_bf16 a[236:239], a[248:251], v[60:63], a[236:239]
    v_add_f32 v32, 0xc1300000, v32
    v_mov_b32 v33, v32
    s_waitcnt lgkmcnt(2)
    v_mfma_f32_16x16x32_bf16 v[240:243], v[226:229], a[80:83], 0
    v_mov_b32 v34, v32
    v_mov_b32 v35, v32
    v_mfma_f32_16x16x32_bf16 v[240:243], v[230:233], a[80:83], v[240:243]
    v_add_f32 v40, v40, v32
    v_add_f32 v41, v41, v32
    v_mfma_f32_16x16x32_bf16 v[244:247], v[224:227], a[80:83], 0
    v_add_f32 v42, v42, v32
    v_add_f32 v43, v43, v32
    v_mfma_f32_16x16x32_bf16 v[244:247], v[228:231], a[80:83], v[244:247]
    v_add_f32 v44, v44, v32
    v_add_f32 v45, v45, v32
    v_mfma_f32_16x16x32_bf16 v[48:51], a[128:131], a[64:67], v[32:35]
    v_cvt_pk_bf16_f32 v240, v240, v241
    v_cvt_pk_bf16_f32 v242, v242, v243
    v_mfma_f32_16x16x32_bf16 v[48:51], a[132:135], a[68:71], v[48:51]
    v_accvgpr_write_b32 a80, v240
    v_accvgpr_write_b32 a81, v242
    v_mfma_f32_16x16x32_bf16 v[48:51], a[136:139], a[72:75], v[48:51]
    v_cvt_pk_bf16_f32 v244, v244, v245
    v_cvt_pk_bf16_f32 v246, v246, v247
    v_mfma_f32_16x16x32_bf16 v[48:51], a[140:143], a[76:79], v[48:51]
    v_accvgpr_write_b32 a82, v244
    v_accvgpr_write_b32 a83, v246
    v_mfma_f32_16x16x32_bf16 v[52:55], a[144:147], a[64:67], v[32:35]
    v_add_f32 v46, v46, v32
    v_add_f32 v47, v47, v32
    v_mfma_f32_16x16x32_bf16 v[52:55], a[148:151], a[68:71], v[52:55]
    v_exp_f32 v40, v40
    v_mfma_f32_16x16x32_bf16 v[52:55], a[152:155], a[72:75], v[52:55]
    v_exp_f32 v41, v41
    v_mfma_f32_16x16x32_bf16 v[52:55], a[156:159], a[76:79], v[52:55]
    v_exp_f32 v42, v42
    v_mfma_f32_16x16x32_bf16 v[248:251], v[226:229], a[84:87], 0
    v_exp_f32 v43, v43
    v_mfma_f32_16x16x32_bf16 v[248:251], v[230:233], a[84:87], v[248:251]
    v_exp_f32 v44, v44
    v_mfma_f32_16x16x32_bf16 v[252:255], v[224:227], a[84:87], 0
    v_exp_f32 v45, v45
    v_mfma_f32_16x16x32_bf16 v[252:255], v[228:231], a[84:87], v[252:255]
    v_exp_f32 v46, v46
    s_waitcnt lgkmcnt(0)
    v_mfma_f32_16x16x32_bf16 v[240:243], v[226:229], a[88:91], 0
    v_exp_f32 v47, v47
    v_mfma_f32_16x16x32_bf16 v[240:243], v[230:233], a[88:91], v[240:243]
    v_cvt_pk_bf16_f32 v248, v248, v249
    v_cvt_pk_bf16_f32 v250, v250, v251
    v_mfma_f32_16x16x32_bf16 v[244:247], v[224:227], a[88:91], 0
    v_accvgpr_write_b32 a84, v248
    v_accvgpr_write_b32 a85, v250
    v_mfma_f32_16x16x32_bf16 v[244:247], v[228:231], a[88:91], v[244:247]
    v_cvt_pk_bf16_f32 v252, v252, v253
    v_cvt_pk_bf16_f32 v254, v254, v255
    v_mfma_f32_16x16x32_bf16 v[248:251], v[226:229], a[92:95], 0
    v_accvgpr_write_b32 a86, v252
    v_accvgpr_write_b32 a87, v254
    v_mfma_f32_16x16x32_bf16 v[248:251], v[230:233], a[92:95], v[248:251]
    v_cvt_pk_bf16_f32 v56, v40, v41
    v_cvt_pk_bf16_f32 v57, v42, v43
    v_mfma_f32_16x16x32_bf16 v[252:255], v[224:227], a[92:95], 0
    v_cvt_pk_bf16_f32 v58, v44, v45
    v_cvt_pk_bf16_f32 v59, v46, v47
    v_mfma_f32_16x16x32_bf16 v[252:255], v[228:231], a[92:95], v[252:255]
    v_cvt_pk_bf16_f32 v240, v240, v241
    v_cvt_pk_bf16_f32 v242, v242, v243
    v_mfma_f32_16x16x32_bf16 v[192:195], a[160:163], v[56:59], v[12:15]
    v_cvt_pk_bf16_f32 v244, v244, v245
    v_cvt_pk_bf16_f32 v246, v246, v247
    v_mfma_f32_16x16x32_bf16 v[196:199], a[164:167], v[56:59], v[12:15]
    v_accvgpr_write_b32 a88, v240
    v_accvgpr_write_b32 a89, v242
    v_mfma_f32_16x16x32_bf16 v[200:203], a[168:171], v[56:59], v[12:15]
    v_accvgpr_write_b32 a90, v244
    v_accvgpr_write_b32 a91, v246
    v_mfma_f32_16x16x32_bf16 v[204:207], a[172:175], v[56:59], v[12:15]
    v_cvt_pk_bf16_f32 v248, v248, v249
    v_cvt_pk_bf16_f32 v250, v250, v251
    v_mfma_f32_16x16x32_bf16 v[208:211], a[176:179], v[56:59], v[12:15]
    v_cvt_pk_bf16_f32 v252, v252, v253
    v_cvt_pk_bf16_f32 v254, v254, v255
    v_mfma_f32_16x16x32_bf16 v[212:215], a[180:183], v[56:59], v[12:15]
    v_accvgpr_write_b32 a92, v248
    v_accvgpr_write_b32 a93, v250
    v_mfma_f32_16x16x32_bf16 v[216:219], a[184:187], v[56:59], v[12:15]
    v_accvgpr_write_b32 a94, v252
    v_accvgpr_write_b32 a95, v254
    v_mfma_f32_16x16x32_bf16 v[220:223], a[188:191], v[56:59], v[12:15]
    v_exp_f32 v48, v48
    v_mfma_f32_16x16x32_bf16 a[240:243], a[248:251], v[56:59], 0
    v_exp_f32 v49, v49
    v_mfma_f32_16x16x32_bf16 v[40:43], a[96:99], a[80:83], 0
    v_exp_f32 v50, v50
    v_mfma_f32_16x16x32_bf16 v[40:43], a[100:103], a[84:87], v[40:43]
    v_exp_f32 v51, v51
    v_mfma_f32_16x16x32_bf16 v[40:43], a[104:107], a[88:91], v[40:43]
    v_exp_f32 v52, v52
    v_mfma_f32_16x16x32_bf16 v[40:43], a[108:111], a[92:95], v[40:43]
    v_exp_f32 v53, v53
    v_mfma_f32_16x16x32_bf16 v[44:47], a[112:115], a[80:83], 0
    v_exp_f32 v54, v54
    v_mfma_f32_16x16x32_bf16 v[44:47], a[116:119], a[84:87], v[44:47]
    v_exp_f32 v55, v55
    v_mfma_f32_16x16x32_bf16 v[44:47], a[120:123], a[88:91], v[44:47]
    v_cvt_pk_bf16_f32 v60, v48, v49
    v_cvt_pk_bf16_f32 v61, v50, v51
    v_mfma_f32_16x16x32_bf16 v[44:47], a[124:127], a[92:95], v[44:47]
    v_cvt_pk_bf16_f32 v62, v52, v53
    v_cvt_pk_bf16_f32 v63, v54, v55
    v_max3_f32 v0, v40, v41, v42
    s_nop 0
    v_mfma_f32_16x16x32_bf16 v[192:195], a[192:195], v[60:63], v[192:195]
    v_mfma_f32_16x16x32_bf16 v[196:199], a[196:199], v[60:63], v[196:199]
    s_waitcnt vmcnt(6)
    s_barrier
    v_mfma_f32_16x16x32_bf16 v[200:203], a[200:203], v[60:63], v[200:203]
    ds_read_b128 a[96:99], v4 offset:16384
    v_max3_f32 v1, v43, v44, v45
    v_mfma_f32_16x16x32_bf16 v[204:207], a[204:207], v[60:63], v[204:207]
    ds_read_b128 a[100:103], v5 offset:16384
    v_max3_f32 v0, v0, v46, v47
    v_mfma_f32_16x16x32_bf16 v[208:211], a[208:211], v[60:63], v[208:211]
    ds_read_b128 a[104:107], v6 offset:16384
    v_max_f32 v0, v0, v1
    v_mfma_f32_16x16x32_bf16 v[212:215], a[212:215], v[60:63], v[212:215]
    ds_read_b128 a[108:111], v7 offset:16384
    v_mov_b32 v1, v0
    v_mfma_f32_16x16x32_bf16 v[216:219], a[216:219], v[60:63], v[216:219]
    ds_read_b128 a[112:115], v4 offset:20480
    v_xor_b32 v4, s23, v4
    v_mfma_f32_16x16x32_bf16 v[220:223], a[220:223], v[60:63], v[220:223]
    ds_read_b128 a[116:119], v5 offset:20480
    v_xor_b32 v5, s23, v5
    v_mfma_f32_16x16x32_bf16 a[240:243], a[248:251], v[60:63], a[240:243]
    ds_read_b128 a[120:123], v6 offset:20480
    v_permlane32_swap_b32 v0, v1
    v_max_f32 v0, v0, v1
    v_mov_b32 v1, v0
    ds_read_b128 a[124:127], v7 offset:20480
    v_xor_b32 v6, s23, v6
    v_permlane16_swap_b32 v0, v1
    v_max_f32 v0, v0, v1
    v_min_f32 v36, -v0, v36
    v_add_f32 v36, 0xc1300000, v36
    v_mov_b32 v37, v36
    v_mov_b32 v38, v36
    v_mov_b32 v39, v36
    v_add_f32 v40, v40, v36
    v_add_f32 v41, v41, v36
    v_mfma_f32_16x16x32_bf16 v[48:51], a[128:131], a[80:83], v[36:39]
    v_add_f32 v42, v42, v36
    v_add_f32 v43, v43, v36
    v_mfma_f32_16x16x32_bf16 v[48:51], a[132:135], a[84:87], v[48:51]
    v_add_f32 v44, v44, v36
    v_add_f32 v45, v45, v36
    v_mfma_f32_16x16x32_bf16 v[48:51], a[136:139], a[88:91], v[48:51]
    v_add_f32 v46, v46, v36
    v_add_f32 v47, v47, v36
    v_mfma_f32_16x16x32_bf16 v[48:51], a[140:143], a[92:95], v[48:51]
    v_exp_f32 v40, v40
    v_mfma_f32_16x16x32_bf16 v[52:55], a[144:147], a[80:83], v[36:39]
    v_exp_f32 v41, v41
    v_mfma_f32_16x16x32_bf16 v[52:55], a[148:151], a[84:87], v[52:55]
    v_exp_f32 v42, v42
    v_mfma_f32_16x16x32_bf16 v[52:55], a[152:155], a[88:91], v[52:55]
    v_exp_f32 v43, v43
    v_mfma_f32_16x16x32_bf16 v[52:55], a[156:159], a[92:95], v[52:55]
    v_exp_f32 v44, v44
    v_exp_f32 v45, v45
    v_exp_f32 v46, v46
    v_exp_f32 v47, v47
    v_cvt_pk_bf16_f32 v56, v40, v41
    v_cvt_pk_bf16_f32 v57, v42, v43
    v_cvt_pk_bf16_f32 v58, v44, v45
    v_cvt_pk_bf16_f32 v59, v46, v47
    v_exp_f32 v48, v48
    v_xor_b32 v7, s23, v7
    v_mfma_f32_16x16x32_bf16 v[224:227], a[160:163], v[56:59], v[12:15]
    v_exp_f32 v49, v49
    v_mfma_f32_16x16x32_bf16 v[228:231], a[164:167], v[56:59], v[12:15]
    s_waitcnt vmcnt(4)
    s_barrier
    v_mfma_f32_16x16x32_bf16 v[232:235], a[168:171], v[56:59], v[12:15]
    s_waitcnt lgkmcnt(0)
    v_exp_f32 v50, v50
    v_mfma_f32_16x16x32_bf16 v[236:239], a[172:175], v[56:59], v[12:15]
    ds_read_b64_tr_b16 a[160:161], v8 offset:16384
    v_mov_b32 v0, 0
    v_mfma_f32_16x16x32_bf16 v[240:243], a[176:179], v[56:59], v[12:15]
    ds_read_b64_tr_b16 a[162:163], v8 offset:20480
    v_mov_b32 v1, 0
    v_mfma_f32_16x16x32_bf16 v[244:247], a[180:183], v[56:59], v[12:15]
    ds_read_b64_tr_b16 a[164:165], v8 offset:16392
    v_cvt_pk_bf16_f32 v60, v48, v49
    v_mfma_f32_16x16x32_bf16 v[248:251], a[184:187], v[56:59], v[12:15]
    ds_read_b64_tr_b16 a[166:167], v8 offset:20488
    v_xor_b32 v8, s23, v8
    v_mfma_f32_16x16x32_bf16 v[252:255], a[188:191], v[56:59], v[12:15]
    ds_read_b64_tr_b16 a[168:169], v9 offset:16384
    v_mfma_f32_16x16x32_bf16 a[244:247], a[248:251], v[56:59], 0
    ds_read_b64_tr_b16 a[170:171], v9 offset:20480
    v_mov_b32 v12, 0
    v_mfma_f32_16x16x32_bf16 v[40:43], a[96:99], a[0:3], v[16:19]
    ds_read_b64_tr_b16 a[172:173], v9 offset:16392
    v_mov_b32 v13, 0
    v_mfma_f32_16x16x32_bf16 v[40:43], a[100:103], a[4:7], v[40:43]
    ds_read_b64_tr_b16 a[174:175], v9 offset:20488
    v_xor_b32 v9, s23, v9
    v_mfma_f32_16x16x32_bf16 v[40:43], a[104:107], a[8:11], v[40:43]
    ds_read_b64_tr_b16 a[176:177], v10 offset:16384
    v_mfma_f32_16x16x32_bf16 v[40:43], a[108:111], a[12:15], v[40:43]
    ds_read_b64_tr_b16 a[178:179], v10 offset:20480
    v_exp_f32 v51, v51
    v_mfma_f32_16x16x32_bf16 v[44:47], a[112:115], a[0:3], v[16:19]
    ds_read_b64_tr_b16 a[180:181], v10 offset:16392
    v_cvt_pk_bf16_f32 v61, v50, v51
    v_mfma_f32_16x16x32_bf16 v[44:47], a[116:119], a[4:7], v[44:47]
    ds_read_b64_tr_b16 a[182:183], v10 offset:20488
    v_xor_b32 v10, s23, v10
    v_mfma_f32_16x16x32_bf16 v[44:47], a[120:123], a[8:11], v[44:47]
    ds_read_b64_tr_b16 a[184:185], v11 offset:16384
    ds_read_b64_tr_b16 a[186:187], v11 offset:20480
    v_mfma_f32_16x16x32_bf16 v[44:47], a[124:127], a[12:15], v[44:47]
    ds_read_b64_tr_b16 a[188:189], v11 offset:16392
    v_exp_f32 v52, v52
    v_exp_f32 v53, v53
    v_exp_f32 v54, v54
    v_exp_f32 v55, v55
    ds_read_b64_tr_b16 a[190:191], v11 offset:20488
    v_xor_b32 v11, s23, v11
    s_mov_b32 s23, 0xc000
    v_cvt_pk_bf16_f32 v62, v52, v53
    v_cvt_pk_bf16_f32 v63, v54, v55
    s_nop 1
.p2align 6
L_loop6:
    v_mfma_f32_16x16x32_bf16 v[224:227], a[192:195], v[60:63], v[224:227]
    s_waitcnt lgkmcnt(0)
    v_mfma_f32_16x16x32_bf16 v[228:231], a[196:199], v[60:63], v[228:231]
    v_mfma_f32_16x16x32_bf16 v[232:235], a[200:203], v[60:63], v[232:235]
    v_exp_f32 v40, v40
    v_mfma_f32_16x16x32_bf16 v[236:239], a[204:207], v[60:63], v[236:239]
    v_exp_f32 v41, v41
    v_mfma_f32_16x16x32_bf16 v[240:243], a[208:211], v[60:63], v[240:243]
    v_exp_f32 v42, v42
    v_mfma_f32_16x16x32_bf16 v[244:247], a[212:215], v[60:63], v[244:247]
    v_exp_f32 v43, v43
    v_mfma_f32_16x16x32_bf16 v[248:251], a[216:219], v[60:63], v[248:251]
    v_exp_f32 v44, v44
    v_mfma_f32_16x16x32_bf16 v[252:255], a[220:223], v[60:63], v[252:255]
    v_exp_f32 v45, v45
    v_mfma_f32_16x16x32_bf16 a[244:247], a[248:251], v[60:63], a[244:247]
    v_exp_f32 v46, v46
    v_mfma_f32_16x16x32_bf16 v[48:51], a[96:99], a[16:19], v[20:23]
    v_exp_f32 v47, v47
    v_mfma_f32_16x16x32_bf16 v[48:51], a[100:103], a[20:23], v[48:51]
    v_cvt_pk_bf16_f32 v56, v40, v41
    v_cvt_pk_bf16_f32 v57, v42, v43
    v_mfma_f32_16x16x32_bf16 v[48:51], a[104:107], a[24:27], v[48:51]
    v_cvt_pk_bf16_f32 v58, v44, v45
    v_cvt_pk_bf16_f32 v59, v46, v47
    v_mfma_f32_16x16x32_bf16 v[48:51], a[108:111], a[28:31], v[48:51]
    v_add_f32 v0, v0, v40
    v_add_f32 v0, v0, v41
    v_mfma_f32_16x16x32_bf16 v[52:55], a[112:115], a[16:19], v[20:23]
    s_waitcnt vmcnt(0)
    v_add_f32 v0, v0, v42
    v_add_f32 v0, v0, v43
    v_mfma_f32_16x16x32_bf16 v[52:55], a[116:119], a[20:23], v[52:55]
    s_barrier
    v_mfma_f32_16x16x32_bf16 v[52:55], a[120:123], a[24:27], v[52:55]
    ds_read_b128 a[128:131], v4 offset:8192
    v_add_f32 v0, v0, v44
    v_mfma_f32_16x16x32_bf16 v[52:55], a[124:127], a[28:31], v[52:55]
    v_exp_f32 v48, v48
    v_mfma_f32_16x16x32_bf16 v[64:67], a[160:163], v[56:59], v[64:67]
    ds_read_b128 a[132:135], v5 offset:8192
    v_add_f32 v0, v0, v45
    v_mfma_f32_16x16x32_bf16 v[68:71], a[164:167], v[56:59], v[68:71]
    v_exp_f32 v49, v49
    v_mfma_f32_16x16x32_bf16 v[72:75], a[168:171], v[56:59], v[72:75]
    ds_read_b128 a[136:139], v6 offset:8192
    v_add_f32 v0, v0, v46
    v_mfma_f32_16x16x32_bf16 v[76:79], a[172:175], v[56:59], v[76:79]
    v_exp_f32 v50, v50
    v_mfma_f32_16x16x32_bf16 v[80:83], a[176:179], v[56:59], v[80:83]
    ds_read_b128 a[140:143], v7 offset:8192
    v_add_f32 v0, v0, v47
    v_mfma_f32_16x16x32_bf16 v[84:87], a[180:183], v[56:59], v[84:87]
    v_exp_f32 v51, v51
    v_mfma_f32_16x16x32_bf16 v[88:91], a[184:187], v[56:59], v[88:91]
    ds_read_b128 a[144:147], v4 offset:12288
    v_cvt_pk_bf16_f32 v60, v48, v49
    v_mfma_f32_16x16x32_bf16 v[92:95], a[188:191], v[56:59], v[92:95]
    v_exp_f32 v52, v52
    v_mfma_f32_16x16x32_bf16 v[40:43], a[96:99], a[32:35], v[24:27]
    v_exp_f32 v53, v53
    v_mfma_f32_16x16x32_bf16 v[40:43], a[100:103], a[36:39], v[40:43]
    v_exp_f32 v54, v54
    v_mfma_f32_16x16x32_bf16 v[40:43], a[104:107], a[40:43], v[40:43]
    v_exp_f32 v55, v55
    v_mfma_f32_16x16x32_bf16 v[40:43], a[108:111], a[44:47], v[40:43]
    v_cvt_pk_bf16_f32 v61, v50, v51
    v_cvt_pk_bf16_f32 v62, v52, v53
    v_mfma_f32_16x16x32_bf16 v[44:47], a[112:115], a[32:35], v[24:27]
    ds_read_b128 a[148:151], v5 offset:12288
    v_cvt_pk_bf16_f32 v63, v54, v55
    v_mfma_f32_16x16x32_bf16 v[44:47], a[116:119], a[36:39], v[44:47]
    v_add_f32 v1, v1, v48
    v_add_f32 v1, v1, v49
    v_mfma_f32_16x16x32_bf16 v[44:47], a[120:123], a[40:43], v[44:47]
    ds_read_b128 a[152:155], v6 offset:12288
    v_add_f32 v1, v1, v50
    v_mfma_f32_16x16x32_bf16 v[44:47], a[124:127], a[44:47], v[44:47]
    v_exp_f32 v40, v40
    v_mfma_f32_16x16x32_bf16 v[96:99], a[160:163], v[60:63], v[96:99]
    ds_read_b128 a[156:159], v7 offset:12288
    v_add_f32 v1, v1, v51
    v_mfma_f32_16x16x32_bf16 v[100:103], a[164:167], v[60:63], v[100:103]
    v_exp_f32 v41, v41
    v_mfma_f32_16x16x32_bf16 v[104:107], a[168:171], v[60:63], v[104:107]
    ds_read_b64_tr_b16 a[192:193], v8 offset:8192
    v_add_f32 v1, v1, v52
    v_mfma_f32_16x16x32_bf16 v[108:111], a[172:175], v[60:63], v[108:111]
    v_exp_f32 v42, v42
    v_mfma_f32_16x16x32_bf16 v[112:115], a[176:179], v[60:63], v[112:115]
    ds_read_b64_tr_b16 a[194:195], v8 offset:12288
    v_add_f32 v1, v1, v53
    v_mfma_f32_16x16x32_bf16 v[116:119], a[180:183], v[60:63], v[116:119]
    v_add_f32 v1, v1, v54
    v_add_f32 v1, v1, v55
    v_mfma_f32_16x16x32_bf16 v[120:123], a[184:187], v[60:63], v[120:123]
    ds_read_b64_tr_b16 a[196:197], v8 offset:8200
    v_cvt_pk_bf16_f32 v56, v40, v41
    v_mfma_f32_16x16x32_bf16 v[124:127], a[188:191], v[60:63], v[124:127]
    v_exp_f32 v43, v43
    v_mfma_f32_16x16x32_bf16 v[48:51], a[96:99], a[48:51], v[28:31]
    v_exp_f32 v44, v44
    v_mfma_f32_16x16x32_bf16 v[48:51], a[100:103], a[52:55], v[48:51]
    s_waitcnt lgkmcnt(3)
    v_exp_f32 v45, v45
    v_mfma_f32_16x16x32_bf16 v[48:51], a[104:107], a[56:59], v[48:51]
    v_exp_f32 v46, v46
    v_mfma_f32_16x16x32_bf16 v[48:51], a[108:111], a[60:63], v[48:51]
    v_exp_f32 v47, v47
    v_mfma_f32_16x16x32_bf16 v[52:55], a[112:115], a[48:51], v[28:31]
    v_cvt_pk_bf16_f32 v57, v42, v43
    v_cvt_pk_bf16_f32 v58, v44, v45
    v_mfma_f32_16x16x32_bf16 v[52:55], a[116:119], a[52:55], v[52:55]
    ds_read_b64_tr_b16 a[198:199], v8 offset:12296
    v_cvt_pk_bf16_f32 v59, v46, v47
    v_mfma_f32_16x16x32_bf16 v[52:55], a[120:123], a[56:59], v[52:55]
    v_exp_f32 v48, v48
    v_mfma_f32_16x16x32_bf16 v[52:55], a[124:127], a[60:63], v[52:55]
    ds_read_b64_tr_b16 a[200:201], v9 offset:8192
    v_add_f32 v2, v2, v40
    v_mfma_f32_16x16x32_bf16 v[128:131], a[160:163], v[56:59], v[128:131]
    v_exp_f32 v49, v49
    v_mfma_f32_16x16x32_bf16 v[132:135], a[164:167], v[56:59], v[132:135]
    ds_read_b64_tr_b16 a[202:203], v9 offset:12288
    v_add_f32 v2, v2, v41
    v_mfma_f32_16x16x32_bf16 v[136:139], a[168:171], v[56:59], v[136:139]
    v_add_f32 v2, v2, v42
    v_add_f32 v2, v2, v43
    v_mfma_f32_16x16x32_bf16 v[140:143], a[172:175], v[56:59], v[140:143]
    ds_read_b64_tr_b16 a[204:205], v9 offset:8200
    v_add_f32 v2, v2, v44
    v_mfma_f32_16x16x32_bf16 v[144:147], a[176:179], v[56:59], v[144:147]
    v_exp_f32 v50, v50
    v_mfma_f32_16x16x32_bf16 v[148:151], a[180:183], v[56:59], v[148:151]
    ds_read_b64_tr_b16 a[206:207], v9 offset:12296
    v_add_f32 v2, v2, v45
    v_mfma_f32_16x16x32_bf16 v[152:155], a[184:187], v[56:59], v[152:155]
    v_add_f32 v2, v2, v46
    v_add_f32 v2, v2, v47
    v_mfma_f32_16x16x32_bf16 v[156:159], a[188:191], v[56:59], v[156:159]
    ds_read_b64_tr_b16 a[208:209], v10 offset:8192
    v_cvt_pk_bf16_f32 v60, v48, v49
    v_mfma_f32_16x16x32_bf16 v[40:43], a[96:99], a[64:67], v[32:35]
    v_exp_f32 v51, v51
    v_mfma_f32_16x16x32_bf16 v[40:43], a[100:103], a[68:71], v[40:43]
    v_exp_f32 v52, v52
    v_mfma_f32_16x16x32_bf16 v[40:43], a[104:107], a[72:75], v[40:43]
    v_exp_f32 v53, v53
    v_mfma_f32_16x16x32_bf16 v[40:43], a[108:111], a[76:79], v[40:43]
    v_exp_f32 v54, v54
    v_mfma_f32_16x16x32_bf16 v[44:47], a[112:115], a[64:67], v[32:35]
    v_exp_f32 v55, v55
    v_mfma_f32_16x16x32_bf16 v[44:47], a[116:119], a[68:71], v[44:47]
    v_cvt_pk_bf16_f32 v61, v50, v51
    v_cvt_pk_bf16_f32 v62, v52, v53
    v_mfma_f32_16x16x32_bf16 v[44:47], a[120:123], a[72:75], v[44:47]
    ds_read_b64_tr_b16 a[210:211], v10 offset:12288
    v_cvt_pk_bf16_f32 v63, v54, v55
    v_mfma_f32_16x16x32_bf16 v[44:47], a[124:127], a[76:79], v[44:47]
    v_exp_f32 v40, v40
    v_mfma_f32_16x16x32_bf16 v[160:163], a[160:163], v[60:63], v[160:163]
    ds_read_b64_tr_b16 a[212:213], v10 offset:8200
    v_add_f32 v12, v12, v48
    v_mfma_f32_16x16x32_bf16 v[164:167], a[164:167], v[60:63], v[164:167]
    v_add_f32 v12, v12, v49
    v_add_f32 v12, v12, v50
    v_mfma_f32_16x16x32_bf16 v[168:171], a[168:171], v[60:63], v[168:171]
    ds_read_b64_tr_b16 a[214:215], v10 offset:12296
    v_add_f32 v12, v12, v51
    v_mfma_f32_16x16x32_bf16 v[172:175], a[172:175], v[60:63], v[172:175]
    v_exp_f32 v41, v41
    v_mfma_f32_16x16x32_bf16 v[176:179], a[176:179], v[60:63], v[176:179]
    ds_read_b64_tr_b16 a[216:217], v11 offset:8192
    v_add_f32 v12, v12, v52
    v_mfma_f32_16x16x32_bf16 v[180:183], a[180:183], v[60:63], v[180:183]
    v_add_f32 v12, v12, v53
    v_add_f32 v12, v12, v54
    v_mfma_f32_16x16x32_bf16 v[184:187], a[184:187], v[60:63], v[184:187]
    ds_read_b64_tr_b16 a[218:219], v11 offset:12288
    v_add_f32 v12, v12, v55
    v_mfma_f32_16x16x32_bf16 v[188:191], a[188:191], v[60:63], v[188:191]
    v_exp_f32 v42, v42
    v_mfma_f32_16x16x32_bf16 v[48:51], a[96:99], a[80:83], v[36:39]
    v_exp_f32 v43, v43
    v_mfma_f32_16x16x32_bf16 v[48:51], a[100:103], a[84:87], v[48:51]
    v_exp_f32 v44, v44
    v_mfma_f32_16x16x32_bf16 v[48:51], a[104:107], a[88:91], v[48:51]
    v_exp_f32 v45, v45
    v_mfma_f32_16x16x32_bf16 v[48:51], a[108:111], a[92:95], v[48:51]
    v_exp_f32 v46, v46
    v_mfma_f32_16x16x32_bf16 v[52:55], a[112:115], a[80:83], v[36:39]
    v_exp_f32 v47, v47
    v_mfma_f32_16x16x32_bf16 v[52:55], a[116:119], a[84:87], v[52:55]
    v_cvt_pk_bf16_f32 v56, v40, v41
    v_cvt_pk_bf16_f32 v57, v42, v43
    v_mfma_f32_16x16x32_bf16 v[52:55], a[120:123], a[88:91], v[52:55]
    v_cvt_pk_bf16_f32 v58, v44, v45
    v_cvt_pk_bf16_f32 v59, v46, v47
    v_mfma_f32_16x16x32_bf16 v[52:55], a[124:127], a[92:95], v[52:55]
    ds_read_b64_tr_b16 a[220:221], v11 offset:8200
    v_add_f32 v13, v13, v40
    v_mfma_f32_16x16x32_bf16 v[192:195], a[160:163], v[56:59], v[192:195]
    v_exp_f32 v48, v48
    v_mfma_f32_16x16x32_bf16 v[196:199], a[164:167], v[56:59], v[196:199]
    ds_read_b64_tr_b16 a[222:223], v11 offset:12296
    v_add_f32 v13, v13, v41
    v_mfma_f32_16x16x32_bf16 v[200:203], a[168:171], v[56:59], v[200:203]
    v_add_f32 v13, v13, v42
    v_add_f32 v13, v13, v43
    v_mfma_f32_16x16x32_bf16 v[204:207], a[172:175], v[56:59], v[204:207]
    v_add_f32 v13, v13, v44
    v_add_f32 v13, v13, v45
    v_mfma_f32_16x16x32_bf16 v[208:211], a[176:179], v[56:59], v[208:211]
    v_add_f32 v13, v13, v46
    v_add_f32 v13, v13, v47
    v_mfma_f32_16x16x32_bf16 v[212:215], a[180:183], v[56:59], v[212:215]
    v_exp_f32 v49, v49
    v_mfma_f32_16x16x32_bf16 v[216:219], a[184:187], v[56:59], v[216:219]
    v_exp_f32 v50, v50
    v_mfma_f32_16x16x32_bf16 v[220:223], a[188:191], v[56:59], v[220:223]
    v_exp_f32 v51, v51
    v_mfma_f32_16x16x32_bf16 v[40:43], a[128:131], a[0:3], v[16:19]
    v_exp_f32 v52, v52
    v_mfma_f32_16x16x32_bf16 v[40:43], a[132:135], a[4:7], v[40:43]
    v_exp_f32 v53, v53
    v_mfma_f32_16x16x32_bf16 v[40:43], a[136:139], a[8:11], v[40:43]
    v_exp_f32 v54, v54
    v_mfma_f32_16x16x32_bf16 v[40:43], a[140:143], a[12:15], v[40:43]
    v_exp_f32 v55, v55
    v_mfma_f32_16x16x32_bf16 v[44:47], a[144:147], a[0:3], v[16:19]
    v_cvt_pk_bf16_f32 v60, v48, v49
    v_cvt_pk_bf16_f32 v61, v50, v51
    v_mfma_f32_16x16x32_bf16 v[44:47], a[148:151], a[4:7], v[44:47]
    v_cvt_pk_bf16_f32 v62, v52, v53
    v_cvt_pk_bf16_f32 v63, v54, v55
    v_mfma_f32_16x16x32_bf16 v[44:47], a[152:155], a[8:11], v[44:47]
    v_xor_b32 v4, s23, v4
    v_xor_b32 v5, s23, v5
    v_mfma_f32_16x16x32_bf16 v[44:47], a[156:159], a[12:15], v[44:47]
    v_xor_b32 v6, s23, v6
    v_xor_b32 v7, s23, v7
L_odd6:
    v_mfma_f32_16x16x32_bf16 v[224:227], a[160:163], v[60:63], v[224:227]
    s_waitcnt lgkmcnt(0)
    v_xor_b32 v8, s23, v8
    v_xor_b32 v9, s23, v9
    v_mfma_f32_16x16x32_bf16 v[228:231], a[164:167], v[60:63], v[228:231]
    v_exp_f32 v40, v40
    v_mfma_f32_16x16x32_bf16 v[232:235], a[168:171], v[60:63], v[232:235]
    v_exp_f32 v41, v41
    v_mfma_f32_16x16x32_bf16 v[236:239], a[172:175], v[60:63], v[236:239]
    v_exp_f32 v42, v42
    v_mfma_f32_16x16x32_bf16 v[240:243], a[176:179], v[60:63], v[240:243]
    v_exp_f32 v43, v43
    v_mfma_f32_16x16x32_bf16 v[244:247], a[180:183], v[60:63], v[244:247]
    v_exp_f32 v44, v44
    v_mfma_f32_16x16x32_bf16 v[248:251], a[184:187], v[60:63], v[248:251]
    v_exp_f32 v45, v45
    v_mfma_f32_16x16x32_bf16 v[252:255], a[188:191], v[60:63], v[252:255]
    v_exp_f32 v46, v46
    v_mfma_f32_16x16x32_bf16 a[244:247], a[248:251], v[60:63], a[244:247]
    v_exp_f32 v47, v47
    v_mfma_f32_16x16x32_bf16 v[48:51], a[128:131], a[16:19], v[20:23]
    v_cvt_pk_bf16_f32 v56, v40, v41
    v_cvt_pk_bf16_f32 v57, v42, v43
    v_mfma_f32_16x16x32_bf16 v[48:51], a[132:135], a[20:23], v[48:51]
    v_cvt_pk_bf16_f32 v58, v44, v45
    v_cvt_pk_bf16_f32 v59, v46, v47
    v_mfma_f32_16x16x32_bf16 v[48:51], a[136:139], a[24:27], v[48:51]
    v_add_f32 v0, v0, v40
    v_add_f32 v0, v0, v41
    v_mfma_f32_16x16x32_bf16 v[48:51], a[140:143], a[28:31], v[48:51]
    v_add_f32 v0, v0, v42
    v_add_f32 v0, v0, v43
    v_mfma_f32_16x16x32_bf16 v[52:55], a[144:147], a[16:19], v[20:23]
    s_waitcnt vmcnt(0)
    v_add_f32 v0, v0, v44
    v_add_f32 v0, v0, v45
    v_mfma_f32_16x16x32_bf16 v[52:55], a[148:151], a[20:23], v[52:55]
    s_barrier
    v_mfma_f32_16x16x32_bf16 v[52:55], a[152:155], a[24:27], v[52:55]
    ds_read_b128 a[96:99], v4 offset:0
    v_add_f32 v0, v0, v46
    v_mfma_f32_16x16x32_bf16 v[52:55], a[156:159], a[28:31], v[52:55]
    v_exp_f32 v48, v48
    v_mfma_f32_16x16x32_bf16 v[64:67], a[192:195], v[56:59], v[64:67]
    ds_read_b128 a[100:103], v5 offset:0
    v_add_f32 v0, v0, v47
    v_mfma_f32_16x16x32_bf16 v[68:71], a[196:199], v[56:59], v[68:71]
    v_exp_f32 v49, v49
    v_mfma_f32_16x16x32_bf16 v[72:75], a[200:203], v[56:59], v[72:75]
    ds_read_b128 a[104:107], v6 offset:0
    v_cvt_pk_bf16_f32 v60, v48, v49
    v_mfma_f32_16x16x32_bf16 v[76:79], a[204:207], v[56:59], v[76:79]
    v_exp_f32 v50, v50
    v_mfma_f32_16x16x32_bf16 v[80:83], a[208:211], v[56:59], v[80:83]
    ds_read_b128 a[108:111], v7 offset:0
    v_add_f32 v1, v1, v48
    v_mfma_f32_16x16x32_bf16 v[84:87], a[212:215], v[56:59], v[84:87]
    v_exp_f32 v51, v51
    v_mfma_f32_16x16x32_bf16 v[88:91], a[216:219], v[56:59], v[88:91]
    ds_read_b128 a[112:115], v4 offset:4096
    v_cvt_pk_bf16_f32 v61, v50, v51
    v_mfma_f32_16x16x32_bf16 v[92:95], a[220:223], v[56:59], v[92:95]
    v_exp_f32 v52, v52
    v_mfma_f32_16x16x32_bf16 v[40:43], a[128:131], a[32:35], v[24:27]
    ds_read_b128 a[116:119], v5 offset:4096
    v_add_f32 v1, v1, v49
    v_mfma_f32_16x16x32_bf16 v[40:43], a[132:135], a[36:39], v[40:43]
    v_exp_f32 v53, v53
    v_mfma_f32_16x16x32_bf16 v[40:43], a[136:139], a[40:43], v[40:43]
    ds_read_b128 a[120:123], v6 offset:4096
    v_cvt_pk_bf16_f32 v62, v52, v53
    v_mfma_f32_16x16x32_bf16 v[40:43], a[140:143], a[44:47], v[40:43]
    v_exp_f32 v54, v54
    v_mfma_f32_16x16x32_bf16 v[44:47], a[144:147], a[32:35], v[24:27]
    ds_read_b128 a[124:127], v7 offset:4096
    v_add_f32 v1, v1, v50
    v_mfma_f32_16x16x32_bf16 v[44:47], a[148:151], a[36:39], v[44:47]
    v_exp_f32 v55, v55
    v_mfma_f32_16x16x32_bf16 v[44:47], a[152:155], a[40:43], v[44:47]
    ds_read_b64_tr_b16 a[160:161], v8 offset:0
    v_cvt_pk_bf16_f32 v63, v54, v55
    v_mfma_f32_16x16x32_bf16 v[44:47], a[156:159], a[44:47], v[44:47]
    v_exp_f32 v40, v40
    v_mfma_f32_16x16x32_bf16 v[96:99], a[192:195], v[60:63], v[96:99]
    ds_read_b64_tr_b16 a[162:163], v8 offset:4096
    v_add_f32 v1, v1, v51
    v_mfma_f32_16x16x32_bf16 v[100:103], a[196:199], v[60:63], v[100:103]
    v_exp_f32 v41, v41
    v_mfma_f32_16x16x32_bf16 v[104:107], a[200:203], v[60:63], v[104:107]
    ds_read_b64_tr_b16 a[164:165], v8 offset:8
    v_add_f32 v1, v1, v52
    v_mfma_f32_16x16x32_bf16 v[108:111], a[204:207], v[60:63], v[108:111]
    v_exp_f32 v42, v42
    v_mfma_f32_16x16x32_bf16 v[112:115], a[208:211], v[60:63], v[112:115]
    ds_read_b64_tr_b16 a[166:167], v8 offset:4104
    v_add_f32 v1, v1, v53
    v_mfma_f32_16x16x32_bf16 v[116:119], a[212:215], v[60:63], v[116:119]
    s_waitcnt lgkmcnt(4)
    v_exp_f32 v43, v43
    v_mfma_f32_16x16x32_bf16 v[120:123], a[216:219], v[60:63], v[120:123]
    ds_read_b64_tr_b16 a[168:169], v9 offset:0
    v_add_f32 v1, v1, v54
    v_mfma_f32_16x16x32_bf16 v[124:127], a[220:223], v[60:63], v[124:127]
    v_exp_f32 v44, v44
    v_mfma_f32_16x16x32_bf16 v[48:51], a[128:131], a[48:51], v[28:31]
    ds_read_b64_tr_b16 a[170:171], v9 offset:4096
    v_add_f32 v1, v1, v55
    v_mfma_f32_16x16x32_bf16 v[48:51], a[132:135], a[52:55], v[48:51]
    v_exp_f32 v45, v45
    v_mfma_f32_16x16x32_bf16 v[48:51], a[136:139], a[56:59], v[48:51]
    ds_read_b64_tr_b16 a[172:173], v9 offset:8
    v_cvt_pk_bf16_f32 v56, v40, v41
    v_mfma_f32_16x16x32_bf16 v[48:51], a[140:143], a[60:63], v[48:51]
    v_exp_f32 v46, v46
    v_mfma_f32_16x16x32_bf16 v[52:55], a[144:147], a[48:51], v[28:31]
    ds_read_b64_tr_b16 a[174:175], v9 offset:4104
    v_cvt_pk_bf16_f32 v57, v42, v43
    v_mfma_f32_16x16x32_bf16 v[52:55], a[148:151], a[52:55], v[52:55]
    v_exp_f32 v47, v47
    v_mfma_f32_16x16x32_bf16 v[52:55], a[152:155], a[56:59], v[52:55]
    v_cvt_pk_bf16_f32 v58, v44, v45
    v_cvt_pk_bf16_f32 v59, v46, v47
    v_mfma_f32_16x16x32_bf16 v[52:55], a[156:159], a[60:63], v[52:55]
    v_add_f32 v2, v2, v40
    v_add_f32 v2, v2, v41
    v_mfma_f32_16x16x32_bf16 v[128:131], a[192:195], v[56:59], v[128:131]
    v_add_f32 v2, v2, v42
    v_add_f32 v2, v2, v43
    v_mfma_f32_16x16x32_bf16 v[132:135], a[196:199], v[56:59], v[132:135]
    v_add_f32 v2, v2, v44
    v_add_f32 v2, v2, v45
    v_mfma_f32_16x16x32_bf16 v[136:139], a[200:203], v[56:59], v[136:139]
    v_add_f32 v2, v2, v46
    v_add_f32 v2, v2, v47
    v_mfma_f32_16x16x32_bf16 v[140:143], a[204:207], v[56:59], v[140:143]
    v_exp_f32 v48, v48
    v_mfma_f32_16x16x32_bf16 v[144:147], a[208:211], v[56:59], v[144:147]
    v_exp_f32 v49, v49
    v_mfma_f32_16x16x32_bf16 v[148:151], a[212:215], v[56:59], v[148:151]
    v_exp_f32 v50, v50
    v_mfma_f32_16x16x32_bf16 v[152:155], a[216:219], v[56:59], v[152:155]
    v_exp_f32 v51, v51
    v_mfma_f32_16x16x32_bf16 v[156:159], a[220:223], v[56:59], v[156:159]
    v_exp_f32 v52, v52
    v_mfma_f32_16x16x32_bf16 v[40:43], a[128:131], a[64:67], v[32:35]
    v_exp_f32 v53, v53
    v_mfma_f32_16x16x32_bf16 v[40:43], a[132:135], a[68:71], v[40:43]
    v_exp_f32 v54, v54
    v_mfma_f32_16x16x32_bf16 v[40:43], a[136:139], a[72:75], v[40:43]
    v_exp_f32 v55, v55
    v_mfma_f32_16x16x32_bf16 v[40:43], a[140:143], a[76:79], v[40:43]
    v_cvt_pk_bf16_f32 v60, v48, v49
    v_cvt_pk_bf16_f32 v61, v50, v51
    v_mfma_f32_16x16x32_bf16 v[44:47], a[144:147], a[64:67], v[32:35]
    v_cvt_pk_bf16_f32 v62, v52, v53
    v_cvt_pk_bf16_f32 v63, v54, v55
    v_mfma_f32_16x16x32_bf16 v[44:47], a[148:151], a[68:71], v[44:47]
    v_add_f32 v12, v12, v48
    v_add_f32 v12, v12, v49
    v_mfma_f32_16x16x32_bf16 v[44:47], a[152:155], a[72:75], v[44:47]
    v_add_f32 v12, v12, v50
    v_add_f32 v12, v12, v51
    v_mfma_f32_16x16x32_bf16 v[44:47], a[156:159], a[76:79], v[44:47]
    v_add_f32 v12, v12, v52
    v_add_f32 v12, v12, v53
    v_mfma_f32_16x16x32_bf16 v[160:163], a[192:195], v[60:63], v[160:163]
    v_add_f32 v12, v12, v54
    v_add_f32 v12, v12, v55
    v_mfma_f32_16x16x32_bf16 v[164:167], a[196:199], v[60:63], v[164:167]
    v_exp_f32 v40, v40
    v_mfma_f32_16x16x32_bf16 v[168:171], a[200:203], v[60:63], v[168:171]
    v_exp_f32 v41, v41
    v_mfma_f32_16x16x32_bf16 v[172:175], a[204:207], v[60:63], v[172:175]
    v_exp_f32 v42, v42
    v_mfma_f32_16x16x32_bf16 v[176:179], a[208:211], v[60:63], v[176:179]
    v_exp_f32 v43, v43
    v_mfma_f32_16x16x32_bf16 v[180:183], a[212:215], v[60:63], v[180:183]
    v_exp_f32 v44, v44
    v_mfma_f32_16x16x32_bf16 v[184:187], a[216:219], v[60:63], v[184:187]
    v_exp_f32 v45, v45
    v_mfma_f32_16x16x32_bf16 v[188:191], a[220:223], v[60:63], v[188:191]
    v_exp_f32 v46, v46
    v_mfma_f32_16x16x32_bf16 v[48:51], a[128:131], a[80:83], v[36:39]
    v_exp_f32 v47, v47
    v_mfma_f32_16x16x32_bf16 v[48:51], a[132:135], a[84:87], v[48:51]
    v_cvt_pk_bf16_f32 v56, v40, v41
    v_cvt_pk_bf16_f32 v57, v42, v43
    v_mfma_f32_16x16x32_bf16 v[48:51], a[136:139], a[88:91], v[48:51]
    v_cvt_pk_bf16_f32 v58, v44, v45
    v_cvt_pk_bf16_f32 v59, v46, v47
    v_mfma_f32_16x16x32_bf16 v[48:51], a[140:143], a[92:95], v[48:51]
    v_xor_b32 v10, s23, v10
    v_add_f32 v13, v13, v40
    v_mfma_f32_16x16x32_bf16 v[52:55], a[144:147], a[80:83], v[36:39]
    ds_read_b64_tr_b16 a[176:177], v10 offset:0
    v_add_f32 v13, v13, v41
    v_mfma_f32_16x16x32_bf16 v[52:55], a[148:151], a[84:87], v[52:55]
    v_add_f32 v13, v13, v42
    v_add_f32 v13, v13, v43
    v_mfma_f32_16x16x32_bf16 v[52:55], a[152:155], a[88:91], v[52:55]
    ds_read_b64_tr_b16 a[178:179], v10 offset:4096
    v_xor_b32 v11, s23, v11
    v_mfma_f32_16x16x32_bf16 v[52:55], a[156:159], a[92:95], v[52:55]
    s_xor_b32 s23, s23, 0x8000
    v_exp_f32 v48, v48
    v_mfma_f32_16x16x32_bf16 v[192:195], a[192:195], v[56:59], v[192:195]
    ds_read_b64_tr_b16 a[180:181], v10 offset:8
    v_add_f32 v13, v13, v44
    v_mfma_f32_16x16x32_bf16 v[196:199], a[196:199], v[56:59], v[196:199]
    s_sub_u32 s22, s22, 1
    v_exp_f32 v49, v49
    v_mfma_f32_16x16x32_bf16 v[200:203], a[200:203], v[56:59], v[200:203]
    ds_read_b64_tr_b16 a[182:183], v10 offset:4104
    v_add_f32 v13, v13, v45
    v_mfma_f32_16x16x32_bf16 v[204:207], a[204:207], v[56:59], v[204:207]
    s_cmp_lg_u32 s22, 0
    v_exp_f32 v50, v50
    v_mfma_f32_16x16x32_bf16 v[208:211], a[208:211], v[56:59], v[208:211]
    ds_read_b64_tr_b16 a[184:185], v11 offset:0
    v_add_f32 v13, v13, v46
    v_mfma_f32_16x16x32_bf16 v[212:215], a[212:215], v[56:59], v[212:215]
    v_exp_f32 v51, v51
    v_mfma_f32_16x16x32_bf16 v[216:219], a[216:219], v[56:59], v[216:219]
    ds_read_b64_tr_b16 a[186:187], v11 offset:4096
    v_add_f32 v13, v13, v47
    v_mfma_f32_16x16x32_bf16 v[220:223], a[220:223], v[56:59], v[220:223]
    v_exp_f32 v52, v52
    v_mfma_f32_16x16x32_bf16 v[40:43], a[96:99], a[0:3], v[16:19]
    ds_read_b64_tr_b16 a[188:189], v11 offset:8
    v_cvt_pk_bf16_f32 v60, v48, v49
    v_mfma_f32_16x16x32_bf16 v[40:43], a[100:103], a[4:7], v[40:43]
    v_exp_f32 v53, v53
    v_mfma_f32_16x16x32_bf16 v[40:43], a[104:107], a[8:11], v[40:43]
    ds_read_b64_tr_b16 a[190:191], v11 offset:4104
    v_cvt_pk_bf16_f32 v61, v50, v51
    v_mfma_f32_16x16x32_bf16 v[40:43], a[108:111], a[12:15], v[40:43]
    v_exp_f32 v54, v54
    v_mfma_f32_16x16x32_bf16 v[44:47], a[112:115], a[0:3], v[16:19]
    v_exp_f32 v55, v55
    v_mfma_f32_16x16x32_bf16 v[44:47], a[116:119], a[4:7], v[44:47]
    v_cvt_pk_bf16_f32 v62, v52, v53
    v_cvt_pk_bf16_f32 v63, v54, v55
    v_mfma_f32_16x16x32_bf16 v[44:47], a[120:123], a[8:11], v[44:47]
    v_mfma_f32_16x16x32_bf16 v[44:47], a[124:127], a[12:15], v[44:47]
    s_cbranch_scc1 L_loop6
    v_mfma_f32_16x16x32_bf16 v[224:227], a[192:195], v[60:63], v[224:227]
    s_waitcnt vmcnt(0)
    s_barrier
    v_mfma_f32_16x16x32_bf16 v[228:231], a[196:199], v[60:63], v[228:231]
    ds_read_b128 a[128:131], v4 offset:8192
    v_mov_b32 v15, 0
    v_mfma_f32_16x16x32_bf16 v[232:235], a[200:203], v[60:63], v[232:235]
    ds_read_b128 a[132:135], v5 offset:8192
    v_accvgpr_read_b32 v3, a252
    v_mfma_f32_16x16x32_bf16 v[236:239], a[204:207], v[60:63], v[236:239]
    ds_read_b128 a[136:139], v6 offset:8192
    ds_read_b128 a[140:143], v7 offset:8192
    v_mfma_f32_16x16x32_bf16 v[240:243], a[208:211], v[60:63], v[240:243]
    ds_read_b128 a[144:147], v4 offset:12288
    ds_read_b128 a[148:151], v5 offset:12288
    v_mfma_f32_16x16x32_bf16 v[244:247], a[212:215], v[60:63], v[244:247]
    ds_read_b128 a[152:155], v6 offset:12288
    v_mfma_f32_16x16x32_bf16 v[248:251], a[216:219], v[60:63], v[248:251]
    ds_read_b128 a[156:159], v7 offset:12288
    v_mfma_f32_16x16x32_bf16 v[252:255], a[220:223], v[60:63], v[252:255]
    ds_read_b64_tr_b16 a[192:193], v8 offset:8192
    v_mfma_f32_16x16x32_bf16 a[244:247], a[248:251], v[60:63], a[244:247]
    ds_read_b64_tr_b16 a[194:195], v8 offset:12288
    s_waitcnt lgkmcnt(9)
    v_mfma_f32_16x16x32_bf16 v[48:51], a[128:131], a[0:3], v[16:19]
    ds_read_b64_tr_b16 a[196:197], v8 offset:8200
    s_waitcnt lgkmcnt(9)
    v_mfma_f32_16x16x32_bf16 v[48:51], a[132:135], a[4:7], v[48:51]
    ds_read_b64_tr_b16 a[198:199], v8 offset:12296
    s_waitcnt lgkmcnt(9)
    v_mfma_f32_16x16x32_bf16 v[48:51], a[136:139], a[8:11], v[48:51]
    ds_read_b64_tr_b16 a[200:201], v9 offset:8192
    s_waitcnt lgkmcnt(9)
    v_mfma_f32_16x16x32_bf16 v[48:51], a[140:143], a[12:15], v[48:51]
    ds_read_b64_tr_b16 a[202:203], v9 offset:12288
    v_exp_f32 v40, v40
    s_waitcnt lgkmcnt(9)
    v_mfma_f32_16x16x32_bf16 v[52:55], a[144:147], a[0:3], v[16:19]
    ds_read_b64_tr_b16 a[204:205], v9 offset:8200
    v_exp_f32 v41, v41
    s_waitcnt lgkmcnt(8)
    v_mfma_f32_16x16x32_bf16 v[52:55], a[148:151], a[4:7], v[52:55]
    ds_read_b64_tr_b16 a[206:207], v9 offset:12296
    v_cvt_pk_bf16_f32 v56, v40, v41
    v_mfma_f32_16x16x32_bf16 v[52:55], a[152:155], a[8:11], v[52:55]
    ds_read_b64_tr_b16 a[208:209], v10 offset:8192
    v_mov_b32 v18, v0
    s_waitcnt lgkmcnt(7)
    v_mfma_f32_16x16x32_bf16 v[52:55], a[156:159], a[12:15], v[52:55]
    ds_read_b64_tr_b16 a[210:211], v10 offset:12288
    v_exp_f32 v42, v42
    v_exp_f32 v43, v43
    v_exp_f32 v44, v44
    v_exp_f32 v45, v45
    v_exp_f32 v46, v46
    v_exp_f32 v47, v47
    v_cvt_pk_bf16_f32 v57, v42, v43
    v_cvt_pk_bf16_f32 v58, v44, v45
    v_cvt_pk_bf16_f32 v59, v46, v47
    v_exp_f32 v48, v48
    s_nop 0
    v_mfma_f32_16x16x32_bf16 a[224:227], a[248:251], v[56:59], a[224:227]
    ds_read_b64_tr_b16 a[212:213], v10 offset:8200
    v_mfma_f32_16x16x32_bf16 v[64:67], a[160:163], v[56:59], v[64:67]
    ds_read_b64_tr_b16 a[214:215], v10 offset:12296
    v_mfma_f32_16x16x32_bf16 v[68:71], a[164:167], v[56:59], v[68:71]
    ds_read_b64_tr_b16 a[216:217], v11 offset:8192
    v_mfma_f32_16x16x32_bf16 v[72:75], a[168:171], v[56:59], v[72:75]
    ds_read_b64_tr_b16 a[218:219], v11 offset:12288
    v_mfma_f32_16x16x32_bf16 v[76:79], a[172:175], v[56:59], v[76:79]
    ds_read_b64_tr_b16 a[220:221], v11 offset:8200
    v_mfma_f32_16x16x32_bf16 v[80:83], a[176:179], v[56:59], v[80:83]
    ds_read_b64_tr_b16 a[222:223], v11 offset:12296
    v_mfma_f32_16x16x32_bf16 v[84:87], a[180:183], v[56:59], v[84:87]
    s_mov_b32 vcc_lo, 0x55555555
    v_exp_f32 v49, v49
    v_mfma_f32_16x16x32_bf16 v[88:91], a[184:187], v[56:59], v[88:91]
    s_mov_b32 vcc_hi, 0x55555555
    v_exp_f32 v50, v50
    v_mfma_f32_16x16x32_bf16 v[92:95], a[188:191], v[56:59], v[92:95]
    s_mul_i32 s29, s20, 24576
    v_exp_f32 v51, v51
    v_mfma_f32_16x16x32_bf16 v[40:43], a[96:99], a[16:19], v[20:23]
    v_exp_f32 v52, v52
    v_mfma_f32_16x16x32_bf16 v[40:43], a[100:103], a[20:23], v[40:43]
    v_exp_f32 v53, v53
    v_mfma_f32_16x16x32_bf16 v[40:43], a[104:107], a[24:27], v[40:43]
    v_exp_f32 v54, v54
    v_mfma_f32_16x16x32_bf16 v[40:43], a[108:111], a[28:31], v[40:43]
    v_exp_f32 v55, v55
    v_mfma_f32_16x16x32_bf16 v[44:47], a[112:115], a[16:19], v[20:23]
    v_cvt_pk_bf16_f32 v60, v48, v49
    v_cvt_pk_bf16_f32 v61, v50, v51
    v_mfma_f32_16x16x32_bf16 v[44:47], a[116:119], a[20:23], v[44:47]
    v_cvt_pk_bf16_f32 v62, v52, v53
    v_cvt_pk_bf16_f32 v63, v54, v55
    v_mfma_f32_16x16x32_bf16 v[44:47], a[120:123], a[24:27], v[44:47]
    v_permlane32_swap_b32 v0, v18
    v_mfma_f32_16x16x32_bf16 v[44:47], a[124:127], a[28:31], v[44:47]
    v_add_f32 v0, v0, v18
    v_mov_b32 v18, v0
    v_mfma_f32_16x16x32_bf16 a[224:227], a[248:251], v[60:63], a[224:227]
    v_exp_f32 v40, v40
    v_mfma_f32_16x16x32_bf16 v[64:67], a[192:195], v[60:63], v[64:67]
    v_permlane16_swap_b32 v0, v18
    s_waitcnt lgkmcnt(0)
    v_mfma_f32_16x16x32_bf16 v[68:71], a[196:199], v[60:63], v[68:71]
    v_add_f32 v0, v0, v18
    v_mfma_f32_16x16x32_bf16 v[72:75], a[200:203], v[60:63], v[72:75]
    v_exp_f32 v41, v41
    v_mfma_f32_16x16x32_bf16 v[76:79], a[204:207], v[60:63], v[76:79]
    v_accvgpr_read_b32 v16, a224
    v_add_f32 v16, v16, v0
    v_mfma_f32_16x16x32_bf16 v[80:83], a[208:211], v[60:63], v[80:83]
    v_add_f32 v15, v15, v16
    v_cvt_pk_bf16_f32 v56, v40, v41
    v_mfma_f32_16x16x32_bf16 v[84:87], a[212:215], v[60:63], v[84:87]
    v_rcp_f32 v16, v16
    v_mfma_f32_16x16x32_bf16 v[88:91], a[216:219], v[60:63], v[88:91]
    v_mul_f32 v17, s34, v16
    v_mfma_f32_16x16x32_bf16 v[92:95], a[220:223], v[60:63], v[92:95]
    v_exp_f32 v42, v42
    v_exp_f32 v43, v43
    v_exp_f32 v44, v44
    v_exp_f32 v45, v45
    v_exp_f32 v46, v46
    v_exp_f32 v47, v47
    v_cvt_pk_bf16_f32 v57, v42, v43
    v_cvt_pk_bf16_f32 v58, v44, v45
    v_pk_fma_f32 v[64:65], v[64:65], v[16:17], v[16:17] op_sel:[0,0,1] op_sel_hi:[1,0,1] neg_lo:[0,0,1] neg_hi:[0,0,1]
    v_pk_fma_f32 v[66:67], v[66:67], v[16:17], v[16:17] op_sel:[0,0,1] op_sel_hi:[1,0,1] neg_lo:[0,0,1] neg_hi:[0,0,1]
    v_pk_fma_f32 v[68:69], v[68:69], v[16:17], v[16:17] op_sel:[0,0,1] op_sel_hi:[1,0,1] neg_lo:[0,0,1] neg_hi:[0,0,1]
    v_pk_fma_f32 v[70:71], v[70:71], v[16:17], v[16:17] op_sel:[0,0,1] op_sel_hi:[1,0,1] neg_lo:[0,0,1] neg_hi:[0,0,1]
    v_pk_fma_f32 v[72:73], v[72:73], v[16:17], v[16:17] op_sel:[0,0,1] op_sel_hi:[1,0,1] neg_lo:[0,0,1] neg_hi:[0,0,1]
    v_pk_fma_f32 v[74:75], v[74:75], v[16:17], v[16:17] op_sel:[0,0,1] op_sel_hi:[1,0,1] neg_lo:[0,0,1] neg_hi:[0,0,1]
    v_pk_fma_f32 v[76:77], v[76:77], v[16:17], v[16:17] op_sel:[0,0,1] op_sel_hi:[1,0,1] neg_lo:[0,0,1] neg_hi:[0,0,1]
    v_pk_fma_f32 v[78:79], v[78:79], v[16:17], v[16:17] op_sel:[0,0,1] op_sel_hi:[1,0,1] neg_lo:[0,0,1] neg_hi:[0,0,1]
    v_pk_fma_f32 v[80:81], v[80:81], v[16:17], v[16:17] op_sel:[0,0,1] op_sel_hi:[1,0,1] neg_lo:[0,0,1] neg_hi:[0,0,1]
    v_pk_fma_f32 v[82:83], v[82:83], v[16:17], v[16:17] op_sel:[0,0,1] op_sel_hi:[1,0,1] neg_lo:[0,0,1] neg_hi:[0,0,1]
    v_pk_fma_f32 v[84:85], v[84:85], v[16:17], v[16:17] op_sel:[0,0,1] op_sel_hi:[1,0,1] neg_lo:[0,0,1] neg_hi:[0,0,1]
    v_pk_fma_f32 v[86:87], v[86:87], v[16:17], v[16:17] op_sel:[0,0,1] op_sel_hi:[1,0,1] neg_lo:[0,0,1] neg_hi:[0,0,1]
    v_pk_fma_f32 v[88:89], v[88:89], v[16:17], v[16:17] op_sel:[0,0,1] op_sel_hi:[1,0,1] neg_lo:[0,0,1] neg_hi:[0,0,1]
    v_pk_fma_f32 v[90:91], v[90:91], v[16:17], v[16:17] op_sel:[0,0,1] op_sel_hi:[1,0,1] neg_lo:[0,0,1] neg_hi:[0,0,1]
    v_pk_fma_f32 v[92:93], v[92:93], v[16:17], v[16:17] op_sel:[0,0,1] op_sel_hi:[1,0,1] neg_lo:[0,0,1] neg_hi:[0,0,1]
    v_pk_fma_f32 v[94:95], v[94:95], v[16:17], v[16:17] op_sel:[0,0,1] op_sel_hi:[1,0,1] neg_lo:[0,0,1] neg_hi:[0,0,1]
    v_cvt_pk_bf16_f32 v64, v64, v65
    v_cvt_pk_bf16_f32 v72, v72, v73
    v_cvt_pk_bf16_f32 v65, v66, v67
    v_cvt_pk_bf16_f32 v73, v74, v75
    v_cvt_pk_bf16_f32 v66, v68, v69
    v_cvt_pk_bf16_f32 v67, v70, v71
    v_cvt_pk_bf16_f32 v74, v76, v77
    v_cvt_pk_bf16_f32 v75, v78, v79
    v_cndmask_b32_dpp v68, v72, v64, vcc quad_perm:[1,0,3,2] row_mask:0xf bank_mask:0xf
    v_cndmask_b32_dpp v70, v74, v66, vcc quad_perm:[1,0,3,2] row_mask:0xf bank_mask:0xf
    v_cvt_pk_bf16_f32 v80, v80, v81
    v_cvt_pk_bf16_f32 v88, v88, v89
    v_cndmask_b32_dpp v69, v73, v65, vcc quad_perm:[1,0,3,2] row_mask:0xf bank_mask:0xf
    v_cndmask_b32_dpp v71, v75, v67, vcc quad_perm:[1,0,3,2] row_mask:0xf bank_mask:0xf
    buffer_store_dwordx4 v[68:71], v3, s[16:19], s29 offen offset:0 sc0 sc1 nt
    s_not_b64 vcc, vcc
    v_cvt_pk_bf16_f32 v81, v82, v83
    v_cvt_pk_bf16_f32 v89, v90, v91
    v_cndmask_b32_dpp v72, v64, v72, vcc quad_perm:[1,0,3,2] row_mask:0xf bank_mask:0xf
    v_cndmask_b32_dpp v73, v65, v73, vcc quad_perm:[1,0,3,2] row_mask:0xf bank_mask:0xf
    v_cvt_pk_bf16_f32 v82, v84, v85
    v_cvt_pk_bf16_f32 v83, v86, v87
    v_cndmask_b32_dpp v74, v66, v74, vcc quad_perm:[1,0,3,2] row_mask:0xf bank_mask:0xf
    v_cndmask_b32_dpp v75, v67, v75, vcc quad_perm:[1,0,3,2] row_mask:0xf bank_mask:0xf
    buffer_store_dwordx4 v[72:75], v3, s[16:19], s29 offen offset:256 sc0 sc1 nt
    v_cvt_pk_bf16_f32 v90, v92, v93
    v_cvt_pk_bf16_f32 v91, v94, v95
    s_not_b64 vcc, vcc
    v_cndmask_b32_dpp v84, v88, v80, vcc quad_perm:[1,0,3,2] row_mask:0xf bank_mask:0xf
    v_cndmask_b32_dpp v86, v90, v82, vcc quad_perm:[1,0,3,2] row_mask:0xf bank_mask:0xf
    v_cvt_pk_bf16_f32 v59, v46, v47
    v_cndmask_b32_dpp v85, v89, v81, vcc quad_perm:[1,0,3,2] row_mask:0xf bank_mask:0xf
    v_cndmask_b32_dpp v87, v91, v83, vcc quad_perm:[1,0,3,2] row_mask:0xf bank_mask:0xf
    buffer_store_dwordx4 v[84:87], v3, s[16:19], s29 offen offset:128 sc0 sc1 nt
    s_not_b64 vcc, vcc
    v_cndmask_b32_dpp v88, v80, v88, vcc quad_perm:[1,0,3,2] row_mask:0xf bank_mask:0xf
    v_cndmask_b32_dpp v89, v81, v89, vcc quad_perm:[1,0,3,2] row_mask:0xf bank_mask:0xf
    v_cndmask_b32_dpp v90, v82, v90, vcc quad_perm:[1,0,3,2] row_mask:0xf bank_mask:0xf
    v_cndmask_b32_dpp v91, v83, v91, vcc quad_perm:[1,0,3,2] row_mask:0xf bank_mask:0xf
    buffer_store_dwordx4 v[88:91], v3, s[16:19], s29 offen offset:384 sc0 sc1 nt
    s_not_b64 vcc, vcc
    s_add_u32 s29, s29, 4096
    v_mfma_f32_16x16x32_bf16 v[48:51], a[128:131], a[16:19], v[20:23]
    v_mfma_f32_16x16x32_bf16 v[48:51], a[132:135], a[20:23], v[48:51]
    v_mfma_f32_16x16x32_bf16 v[48:51], a[136:139], a[24:27], v[48:51]
    v_mfma_f32_16x16x32_bf16 v[48:51], a[140:143], a[28:31], v[48:51]
    v_mfma_f32_16x16x32_bf16 v[52:55], a[144:147], a[16:19], v[20:23]
    v_mfma_f32_16x16x32_bf16 v[52:55], a[148:151], a[20:23], v[52:55]
    v_mfma_f32_16x16x32_bf16 v[52:55], a[152:155], a[24:27], v[52:55]
    s_nop 0
    v_mov_b32 v22, v1
    v_mfma_f32_16x16x32_bf16 v[52:55], a[156:159], a[28:31], v[52:55]
    s_nop 0
    v_permlane32_swap_b32 v1, v22
    v_mfma_f32_16x16x32_bf16 a[228:231], a[248:251], v[56:59], a[228:231]
    v_exp_f32 v48, v48
    v_mfma_f32_16x16x32_bf16 v[96:99], a[160:163], v[56:59], v[96:99]
    v_exp_f32 v49, v49
    v_mfma_f32_16x16x32_bf16 v[100:103], a[164:167], v[56:59], v[100:103]
    v_exp_f32 v50, v50
    v_mfma_f32_16x16x32_bf16 v[104:107], a[168:171], v[56:59], v[104:107]
    v_exp_f32 v51, v51
    v_mfma_f32_16x16x32_bf16 v[108:111], a[172:175], v[56:59], v[108:111]
    v_exp_f32 v52, v52
    v_mfma_f32_16x16x32_bf16 v[112:115], a[176:179], v[56:59], v[112:115]
    v_exp_f32 v53, v53
    v_mfma_f32_16x16x32_bf16 v[116:119], a[180:183], v[56:59], v[116:119]
    v_exp_f32 v54, v54
    v_mfma_f32_16x16x32_bf16 v[120:123], a[184:187], v[56:59], v[120:123]
    v_exp_f32 v55, v55
    v_mfma_f32_16x16x32_bf16 v[124:127], a[188:191], v[56:59], v[124:127]
    v_cvt_pk_bf16_f32 v60, v48, v49
    v_cvt_pk_bf16_f32 v61, v50, v51
    v_mfma_f32_16x16x32_bf16 v[40:43], a[96:99], a[32:35], v[24:27]
    v_cvt_pk_bf16_f32 v62, v52, v53
    v_cvt_pk_bf16_f32 v63, v54, v55
    v_mfma_f32_16x16x32_bf16 v[40:43], a[100:103], a[36:39], v[40:43]
    v_add_f32 v1, v1, v22
    v_mov_b32 v22, v1
    v_mfma_f32_16x16x32_bf16 v[40:43], a[104:107], a[40:43], v[40:43]
    s_nop 0
    v_permlane16_swap_b32 v1, v22
    v_mfma_f32_16x16x32_bf16 v[40:43], a[108:111], a[44:47], v[40:43]
    v_add_f32 v1, v1, v22
    v_mfma_f32_16x16x32_bf16 v[44:47], a[112:115], a[32:35], v[24:27]
    v_mfma_f32_16x16x32_bf16 v[44:47], a[116:119], a[36:39], v[44:47]
    v_mfma_f32_16x16x32_bf16 v[44:47], a[120:123], a[40:43], v[44:47]
    v_mfma_f32_16x16x32_bf16 v[44:47], a[124:127], a[44:47], v[44:47]
    v_mfma_f32_16x16x32_bf16 a[228:231], a[248:251], v[60:63], a[228:231]
    v_mfma_f32_16x16x32_bf16 v[96:99], a[192:195], v[60:63], v[96:99]
    s_nop 0
    v_exp_f32 v40, v40
    v_mfma_f32_16x16x32_bf16 v[100:103], a[196:199], v[60:63], v[100:103]
    v_exp_f32 v41, v41
    v_mfma_f32_16x16x32_bf16 v[104:107], a[200:203], v[60:63], v[104:107]
    v_exp_f32 v42, v42
    v_mfma_f32_16x16x32_bf16 v[108:111], a[204:207], v[60:63], v[108:111]
    v_accvgpr_read_b32 v20, a228
    v_add_f32 v20, v20, v1
    v_mfma_f32_16x16x32_bf16 v[112:115], a[208:211], v[60:63], v[112:115]
    v_add_f32 v15, v15, v20
    v_cvt_pk_bf16_f32 v56, v40, v41
    v_mfma_f32_16x16x32_bf16 v[116:119], a[212:215], v[60:63], v[116:119]
    v_rcp_f32 v20, v20
    v_mfma_f32_16x16x32_bf16 v[120:123], a[216:219], v[60:63], v[120:123]
    v_mul_f32 v21, s34, v20
    v_mfma_f32_16x16x32_bf16 v[124:127], a[220:223], v[60:63], v[124:127]
    v_exp_f32 v43, v43
    v_mfma_f32_16x16x32_bf16 v[48:51], a[128:131], a[32:35], v[24:27]
    v_exp_f32 v44, v44
    v_mfma_f32_16x16x32_bf16 v[48:51], a[132:135], a[36:39], v[48:51]
    v_exp_f32 v45, v45
    v_mfma_f32_16x16x32_bf16 v[48:51], a[136:139], a[40:43], v[48:51]
    v_exp_f32 v46, v46
    v_mfma_f32_16x16x32_bf16 v[48:51], a[140:143], a[44:47], v[48:51]
    v_exp_f32 v47, v47
    v_pk_fma_f32 v[96:97], v[96:97], v[20:21], v[20:21] op_sel:[0,0,1] op_sel_hi:[1,0,1] neg_lo:[0,0,1] neg_hi:[0,0,1]
    v_pk_fma_f32 v[98:99], v[98:99], v[20:21], v[20:21] op_sel:[0,0,1] op_sel_hi:[1,0,1] neg_lo:[0,0,1] neg_hi:[0,0,1]
    v_pk_fma_f32 v[100:101], v[100:101], v[20:21], v[20:21] op_sel:[0,0,1] op_sel_hi:[1,0,1] neg_lo:[0,0,1] neg_hi:[0,0,1]
    v_pk_fma_f32 v[102:103], v[102:103], v[20:21], v[20:21] op_sel:[0,0,1] op_sel_hi:[1,0,1] neg_lo:[0,0,1] neg_hi:[0,0,1]
    v_pk_fma_f32 v[104:105], v[104:105], v[20:21], v[20:21] op_sel:[0,0,1] op_sel_hi:[1,0,1] neg_lo:[0,0,1] neg_hi:[0,0,1]
    v_pk_fma_f32 v[106:107], v[106:107], v[20:21], v[20:21] op_sel:[0,0,1] op_sel_hi:[1,0,1] neg_lo:[0,0,1] neg_hi:[0,0,1]
    v_pk_fma_f32 v[108:109], v[108:109], v[20:21], v[20:21] op_sel:[0,0,1] op_sel_hi:[1,0,1] neg_lo:[0,0,1] neg_hi:[0,0,1]
    v_pk_fma_f32 v[110:111], v[110:111], v[20:21], v[20:21] op_sel:[0,0,1] op_sel_hi:[1,0,1] neg_lo:[0,0,1] neg_hi:[0,0,1]
    v_pk_fma_f32 v[112:113], v[112:113], v[20:21], v[20:21] op_sel:[0,0,1] op_sel_hi:[1,0,1] neg_lo:[0,0,1] neg_hi:[0,0,1]
    v_pk_fma_f32 v[114:115], v[114:115], v[20:21], v[20:21] op_sel:[0,0,1] op_sel_hi:[1,0,1] neg_lo:[0,0,1] neg_hi:[0,0,1]
    v_pk_fma_f32 v[116:117], v[116:117], v[20:21], v[20:21] op_sel:[0,0,1] op_sel_hi:[1,0,1] neg_lo:[0,0,1] neg_hi:[0,0,1]
    v_pk_fma_f32 v[118:119], v[118:119], v[20:21], v[20:21] op_sel:[0,0,1] op_sel_hi:[1,0,1] neg_lo:[0,0,1] neg_hi:[0,0,1]
    v_pk_fma_f32 v[120:121], v[120:121], v[20:21], v[20:21] op_sel:[0,0,1] op_sel_hi:[1,0,1] neg_lo:[0,0,1] neg_hi:[0,0,1]
    v_pk_fma_f32 v[122:123], v[122:123], v[20:21], v[20:21] op_sel:[0,0,1] op_sel_hi:[1,0,1] neg_lo:[0,0,1] neg_hi:[0,0,1]
    v_pk_fma_f32 v[124:125], v[124:125], v[20:21], v[20:21] op_sel:[0,0,1] op_sel_hi:[1,0,1] neg_lo:[0,0,1] neg_hi:[0,0,1]
    v_pk_fma_f32 v[126:127], v[126:127], v[20:21], v[20:21] op_sel:[0,0,1] op_sel_hi:[1,0,1] neg_lo:[0,0,1] neg_hi:[0,0,1]
    v_mfma_f32_16x16x32_bf16 v[52:55], a[144:147], a[32:35], v[24:27]
    v_cvt_pk_bf16_f32 v96, v96, v97
    v_cvt_pk_bf16_f32 v104, v104, v105
    v_mfma_f32_16x16x32_bf16 v[52:55], a[148:151], a[36:39], v[52:55]
    v_cvt_pk_bf16_f32 v97, v98, v99
    v_cvt_pk_bf16_f32 v105, v106, v107
    v_mfma_f32_16x16x32_bf16 v[52:55], a[152:155], a[40:43], v[52:55]
    v_cvt_pk_bf16_f32 v98, v100, v101
    v_cvt_pk_bf16_f32 v99, v102, v103
    v_mfma_f32_16x16x32_bf16 v[52:55], a[156:159], a[44:47], v[52:55]
    v_cvt_pk_bf16_f32 v106, v108, v109
    v_cvt_pk_bf16_f32 v107, v110, v111
    v_cndmask_b32_dpp v100, v104, v96, vcc quad_perm:[1,0,3,2] row_mask:0xf bank_mask:0xf
    v_cndmask_b32_dpp v102, v106, v98, vcc quad_perm:[1,0,3,2] row_mask:0xf bank_mask:0xf
    v_cvt_pk_bf16_f32 v112, v112, v113
    v_cvt_pk_bf16_f32 v120, v120, v121
    v_cndmask_b32_dpp v101, v105, v97, vcc quad_perm:[1,0,3,2] row_mask:0xf bank_mask:0xf
    v_cndmask_b32_dpp v103, v107, v99, vcc quad_perm:[1,0,3,2] row_mask:0xf bank_mask:0xf
    buffer_store_dwordx4 v[100:103], v3, s[16:19], s29 offen offset:0 sc0 sc1 nt
    s_not_b64 vcc, vcc
    v_cvt_pk_bf16_f32 v113, v114, v115
    v_cvt_pk_bf16_f32 v121, v122, v123
    v_cndmask_b32_dpp v104, v96, v104, vcc quad_perm:[1,0,3,2] row_mask:0xf bank_mask:0xf
    v_cndmask_b32_dpp v105, v97, v105, vcc quad_perm:[1,0,3,2] row_mask:0xf bank_mask:0xf
    v_cvt_pk_bf16_f32 v114, v116, v117
    v_cvt_pk_bf16_f32 v115, v118, v119
    v_cndmask_b32_dpp v106, v98, v106, vcc quad_perm:[1,0,3,2] row_mask:0xf bank_mask:0xf
    v_cndmask_b32_dpp v107, v99, v107, vcc quad_perm:[1,0,3,2] row_mask:0xf bank_mask:0xf
    buffer_store_dwordx4 v[104:107], v3, s[16:19], s29 offen offset:256 sc0 sc1 nt
    v_cvt_pk_bf16_f32 v122, v124, v125
    v_cvt_pk_bf16_f32 v123, v126, v127
    s_not_b64 vcc, vcc
    v_cndmask_b32_dpp v116, v120, v112, vcc quad_perm:[1,0,3,2] row_mask:0xf bank_mask:0xf
    v_cndmask_b32_dpp v118, v122, v114, vcc quad_perm:[1,0,3,2] row_mask:0xf bank_mask:0xf
    v_cvt_pk_bf16_f32 v57, v42, v43
    v_cvt_pk_bf16_f32 v58, v44, v45
    v_cndmask_b32_dpp v117, v121, v113, vcc quad_perm:[1,0,3,2] row_mask:0xf bank_mask:0xf
    v_cndmask_b32_dpp v119, v123, v115, vcc quad_perm:[1,0,3,2] row_mask:0xf bank_mask:0xf
    buffer_store_dwordx4 v[116:119], v3, s[16:19], s29 offen offset:128 sc0 sc1 nt
    s_not_b64 vcc, vcc
    v_cvt_pk_bf16_f32 v59, v46, v47
    v_exp_f32 v48, v48
    v_cndmask_b32_dpp v120, v112, v120, vcc quad_perm:[1,0,3,2] row_mask:0xf bank_mask:0xf
    v_cndmask_b32_dpp v121, v113, v121, vcc quad_perm:[1,0,3,2] row_mask:0xf bank_mask:0xf
    v_exp_f32 v49, v49
    v_exp_f32 v50, v50
    v_cndmask_b32_dpp v122, v114, v122, vcc quad_perm:[1,0,3,2] row_mask:0xf bank_mask:0xf
    v_cndmask_b32_dpp v123, v115, v123, vcc quad_perm:[1,0,3,2] row_mask:0xf bank_mask:0xf
    buffer_store_dwordx4 v[120:123], v3, s[16:19], s29 offen offset:384 sc0 sc1 nt
    s_not_b64 vcc, vcc
    s_add_u32 s29, s29, 4096
    v_mfma_f32_16x16x32_bf16 a[232:235], a[248:251], v[56:59], a[232:235]
    v_exp_f32 v51, v51
    v_mfma_f32_16x16x32_bf16 v[128:131], a[160:163], v[56:59], v[128:131]
    v_exp_f32 v52, v52
    v_mfma_f32_16x16x32_bf16 v[132:135], a[164:167], v[56:59], v[132:135]
    v_exp_f32 v53, v53
    v_mfma_f32_16x16x32_bf16 v[136:139], a[168:171], v[56:59], v[136:139]
    v_exp_f32 v54, v54
    v_mfma_f32_16x16x32_bf16 v[140:143], a[172:175], v[56:59], v[140:143]
    v_exp_f32 v55, v55
    v_mfma_f32_16x16x32_bf16 v[144:147], a[176:179], v[56:59], v[144:147]
    v_cvt_pk_bf16_f32 v60, v48, v49
    v_cvt_pk_bf16_f32 v61, v50, v51
    v_mfma_f32_16x16x32_bf16 v[148:151], a[180:183], v[56:59], v[148:151]
    v_cvt_pk_bf16_f32 v62, v52, v53
    v_cvt_pk_bf16_f32 v63, v54, v55
    v_mfma_f32_16x16x32_bf16 v[152:155], a[184:187], v[56:59], v[152:155]
    v_mov_b32 v26, v2
    v_mfma_f32_16x16x32_bf16 v[156:159], a[188:191], v[56:59], v[156:159]
    s_nop 0
    v_permlane32_swap_b32 v2, v26
    v_mfma_f32_16x16x32_bf16 v[40:43], a[96:99], a[48:51], v[28:31]
    v_add_f32 v2, v2, v26
    v_mov_b32 v26, v2
    v_mfma_f32_16x16x32_bf16 v[40:43], a[100:103], a[52:55], v[40:43]
    s_nop 0
    v_permlane16_swap_b32 v2, v26
    v_mfma_f32_16x16x32_bf16 v[40:43], a[104:107], a[56:59], v[40:43]
    v_add_f32 v2, v2, v26
    v_mfma_f32_16x16x32_bf16 v[40:43], a[108:111], a[60:63], v[40:43]
    v_mfma_f32_16x16x32_bf16 v[44:47], a[112:115], a[48:51], v[28:31]
    v_mfma_f32_16x16x32_bf16 v[44:47], a[116:119], a[52:55], v[44:47]
    v_mfma_f32_16x16x32_bf16 v[44:47], a[120:123], a[56:59], v[44:47]
    v_mfma_f32_16x16x32_bf16 v[44:47], a[124:127], a[60:63], v[44:47]
    v_mfma_f32_16x16x32_bf16 a[232:235], a[248:251], v[60:63], a[232:235]
    v_mfma_f32_16x16x32_bf16 v[128:131], a[192:195], v[60:63], v[128:131]
    v_mfma_f32_16x16x32_bf16 v[132:135], a[196:199], v[60:63], v[132:135]
    s_nop 0
    v_exp_f32 v40, v40
    v_mfma_f32_16x16x32_bf16 v[136:139], a[200:203], v[60:63], v[136:139]
    v_exp_f32 v41, v41
    v_mfma_f32_16x16x32_bf16 v[140:143], a[204:207], v[60:63], v[140:143]
    v_exp_f32 v42, v42
    v_mfma_f32_16x16x32_bf16 v[144:147], a[208:211], v[60:63], v[144:147]
    v_accvgpr_read_b32 v24, a232
    v_add_f32 v24, v24, v2
    v_mfma_f32_16x16x32_bf16 v[148:151], a[212:215], v[60:63], v[148:151]
    v_add_f32 v15, v15, v24
    v_cvt_pk_bf16_f32 v56, v40, v41
    v_mfma_f32_16x16x32_bf16 v[152:155], a[216:219], v[60:63], v[152:155]
    v_rcp_f32 v24, v24
    v_mfma_f32_16x16x32_bf16 v[156:159], a[220:223], v[60:63], v[156:159]
    v_mul_f32 v25, s34, v24
    v_mfma_f32_16x16x32_bf16 v[48:51], a[128:131], a[48:51], v[28:31]
    v_exp_f32 v43, v43
    v_mfma_f32_16x16x32_bf16 v[48:51], a[132:135], a[52:55], v[48:51]
    v_exp_f32 v44, v44
    v_mfma_f32_16x16x32_bf16 v[48:51], a[136:139], a[56:59], v[48:51]
    v_exp_f32 v45, v45
    v_mfma_f32_16x16x32_bf16 v[48:51], a[140:143], a[60:63], v[48:51]
    v_exp_f32 v46, v46
    v_pk_fma_f32 v[128:129], v[128:129], v[24:25], v[24:25] op_sel:[0,0,1] op_sel_hi:[1,0,1] neg_lo:[0,0,1] neg_hi:[0,0,1]
    v_pk_fma_f32 v[130:131], v[130:131], v[24:25], v[24:25] op_sel:[0,0,1] op_sel_hi:[1,0,1] neg_lo:[0,0,1] neg_hi:[0,0,1]
    v_pk_fma_f32 v[132:133], v[132:133], v[24:25], v[24:25] op_sel:[0,0,1] op_sel_hi:[1,0,1] neg_lo:[0,0,1] neg_hi:[0,0,1]
    v_pk_fma_f32 v[134:135], v[134:135], v[24:25], v[24:25] op_sel:[0,0,1] op_sel_hi:[1,0,1] neg_lo:[0,0,1] neg_hi:[0,0,1]
    v_pk_fma_f32 v[136:137], v[136:137], v[24:25], v[24:25] op_sel:[0,0,1] op_sel_hi:[1,0,1] neg_lo:[0,0,1] neg_hi:[0,0,1]
    v_pk_fma_f32 v[138:139], v[138:139], v[24:25], v[24:25] op_sel:[0,0,1] op_sel_hi:[1,0,1] neg_lo:[0,0,1] neg_hi:[0,0,1]
    v_pk_fma_f32 v[140:141], v[140:141], v[24:25], v[24:25] op_sel:[0,0,1] op_sel_hi:[1,0,1] neg_lo:[0,0,1] neg_hi:[0,0,1]
    v_pk_fma_f32 v[142:143], v[142:143], v[24:25], v[24:25] op_sel:[0,0,1] op_sel_hi:[1,0,1] neg_lo:[0,0,1] neg_hi:[0,0,1]
    v_pk_fma_f32 v[144:145], v[144:145], v[24:25], v[24:25] op_sel:[0,0,1] op_sel_hi:[1,0,1] neg_lo:[0,0,1] neg_hi:[0,0,1]
    v_pk_fma_f32 v[146:147], v[146:147], v[24:25], v[24:25] op_sel:[0,0,1] op_sel_hi:[1,0,1] neg_lo:[0,0,1] neg_hi:[0,0,1]
    v_pk_fma_f32 v[148:149], v[148:149], v[24:25], v[24:25] op_sel:[0,0,1] op_sel_hi:[1,0,1] neg_lo:[0,0,1] neg_hi:[0,0,1]
    v_pk_fma_f32 v[150:151], v[150:151], v[24:25], v[24:25] op_sel:[0,0,1] op_sel_hi:[1,0,1] neg_lo:[0,0,1] neg_hi:[0,0,1]
    v_pk_fma_f32 v[152:153], v[152:153], v[24:25], v[24:25] op_sel:[0,0,1] op_sel_hi:[1,0,1] neg_lo:[0,0,1] neg_hi:[0,0,1]
    v_pk_fma_f32 v[154:155], v[154:155], v[24:25], v[24:25] op_sel:[0,0,1] op_sel_hi:[1,0,1] neg_lo:[0,0,1] neg_hi:[0,0,1]
    v_pk_fma_f32 v[156:157], v[156:157], v[24:25], v[24:25] op_sel:[0,0,1] op_sel_hi:[1,0,1] neg_lo:[0,0,1] neg_hi:[0,0,1]
    v_pk_fma_f32 v[158:159], v[158:159], v[24:25], v[24:25] op_sel:[0,0,1] op_sel_hi:[1,0,1] neg_lo:[0,0,1] neg_hi:[0,0,1]
    v_mfma_f32_16x16x32_bf16 v[52:55], a[144:147], a[48:51], v[28:31]
    v_cvt_pk_bf16_f32 v128, v128, v129
    v_cvt_pk_bf16_f32 v136, v136, v137
    v_mfma_f32_16x16x32_bf16 v[52:55], a[148:151], a[52:55], v[52:55]
    v_cvt_pk_bf16_f32 v129, v130, v131
    v_cvt_pk_bf16_f32 v137, v138, v139
    v_mfma_f32_16x16x32_bf16 v[52:55], a[152:155], a[56:59], v[52:55]
    v_cvt_pk_bf16_f32 v130, v132, v133
    v_cvt_pk_bf16_f32 v131, v134, v135
    v_mfma_f32_16x16x32_bf16 v[52:55], a[156:159], a[60:63], v[52:55]
    v_cvt_pk_bf16_f32 v138, v140, v141
    v_cvt_pk_bf16_f32 v139, v142, v143
    v_cndmask_b32_dpp v132, v136, v128, vcc quad_perm:[1,0,3,2] row_mask:0xf bank_mask:0xf
    v_cndmask_b32_dpp v134, v138, v130, vcc quad_perm:[1,0,3,2] row_mask:0xf bank_mask:0xf
    v_cvt_pk_bf16_f32 v144, v144, v145
    v_cvt_pk_bf16_f32 v152, v152, v153
    v_cndmask_b32_dpp v133, v137, v129, vcc quad_perm:[1,0,3,2] row_mask:0xf bank_mask:0xf
    v_cndmask_b32_dpp v135, v139, v131, vcc quad_perm:[1,0,3,2] row_mask:0xf bank_mask:0xf
    buffer_store_dwordx4 v[132:135], v3, s[16:19], s29 offen offset:0 sc0 sc1 nt
    s_not_b64 vcc, vcc
    v_cvt_pk_bf16_f32 v145, v146, v147
    v_cvt_pk_bf16_f32 v153, v154, v155
    v_cndmask_b32_dpp v136, v128, v136, vcc quad_perm:[1,0,3,2] row_mask:0xf bank_mask:0xf
    v_cndmask_b32_dpp v137, v129, v137, vcc quad_perm:[1,0,3,2] row_mask:0xf bank_mask:0xf
    v_cvt_pk_bf16_f32 v146, v148, v149
    v_cvt_pk_bf16_f32 v147, v150, v151
    v_cndmask_b32_dpp v138, v130, v138, vcc quad_perm:[1,0,3,2] row_mask:0xf bank_mask:0xf
    v_cndmask_b32_dpp v139, v131, v139, vcc quad_perm:[1,0,3,2] row_mask:0xf bank_mask:0xf
    buffer_store_dwordx4 v[136:139], v3, s[16:19], s29 offen offset:256 sc0 sc1 nt
    v_cvt_pk_bf16_f32 v154, v156, v157
    v_cvt_pk_bf16_f32 v155, v158, v159
    s_not_b64 vcc, vcc
    v_cndmask_b32_dpp v148, v152, v144, vcc quad_perm:[1,0,3,2] row_mask:0xf bank_mask:0xf
    v_cndmask_b32_dpp v150, v154, v146, vcc quad_perm:[1,0,3,2] row_mask:0xf bank_mask:0xf
    v_exp_f32 v47, v47
    v_cvt_pk_bf16_f32 v57, v42, v43
    v_cndmask_b32_dpp v149, v153, v145, vcc quad_perm:[1,0,3,2] row_mask:0xf bank_mask:0xf
    v_cndmask_b32_dpp v151, v155, v147, vcc quad_perm:[1,0,3,2] row_mask:0xf bank_mask:0xf
    buffer_store_dwordx4 v[148:151], v3, s[16:19], s29 offen offset:128 sc0 sc1 nt
    s_not_b64 vcc, vcc
    v_cvt_pk_bf16_f32 v58, v44, v45
    v_cvt_pk_bf16_f32 v59, v46, v47
    v_cndmask_b32_dpp v152, v144, v152, vcc quad_perm:[1,0,3,2] row_mask:0xf bank_mask:0xf
    v_cndmask_b32_dpp v153, v145, v153, vcc quad_perm:[1,0,3,2] row_mask:0xf bank_mask:0xf
    v_exp_f32 v48, v48
    v_exp_f32 v49, v49
    v_cndmask_b32_dpp v154, v146, v154, vcc quad_perm:[1,0,3,2] row_mask:0xf bank_mask:0xf
    v_cndmask_b32_dpp v155, v147, v155, vcc quad_perm:[1,0,3,2] row_mask:0xf bank_mask:0xf
    buffer_store_dwordx4 v[152:155], v3, s[16:19], s29 offen offset:384 sc0 sc1 nt
    s_not_b64 vcc, vcc
    s_add_u32 s29, s29, 4096
    v_mfma_f32_16x16x32_bf16 a[236:239], a[248:251], v[56:59], a[236:239]
    v_exp_f32 v50, v50
    v_mfma_f32_16x16x32_bf16 v[160:163], a[160:163], v[56:59], v[160:163]
    v_exp_f32 v51, v51
    v_mfma_f32_16x16x32_bf16 v[164:167], a[164:167], v[56:59], v[164:167]
    v_exp_f32 v52, v52
    v_mfma_f32_16x16x32_bf16 v[168:171], a[168:171], v[56:59], v[168:171]
    v_exp_f32 v53, v53
    v_mfma_f32_16x16x32_bf16 v[172:175], a[172:175], v[56:59], v[172:175]
    v_exp_f32 v54, v54
    v_mfma_f32_16x16x32_bf16 v[176:179], a[176:179], v[56:59], v[176:179]
    v_exp_f32 v55, v55
    v_mfma_f32_16x16x32_bf16 v[180:183], a[180:183], v[56:59], v[180:183]
    v_cvt_pk_bf16_f32 v60, v48, v49
    v_cvt_pk_bf16_f32 v61, v50, v51
    v_mfma_f32_16x16x32_bf16 v[184:187], a[184:187], v[56:59], v[184:187]
    v_cvt_pk_bf16_f32 v62, v52, v53
    v_cvt_pk_bf16_f32 v63, v54, v55
    v_mfma_f32_16x16x32_bf16 v[188:191], a[188:191], v[56:59], v[188:191]
    v_mov_b32 v30, v12
    v_mfma_f32_16x16x32_bf16 v[40:43], a[96:99], a[64:67], v[32:35]
    s_nop 0
    v_permlane32_swap_b32 v12, v30
    v_mfma_f32_16x16x32_bf16 v[40:43], a[100:103], a[68:71], v[40:43]
    v_add_f32 v12, v12, v30
    v_mov_b32 v30, v12
    v_mfma_f32_16x16x32_bf16 v[40:43], a[104:107], a[72:75], v[40:43]
    s_nop 0
    v_permlane16_swap_b32 v12, v30
    v_mfma_f32_16x16x32_bf16 v[40:43], a[108:111], a[76:79], v[40:43]
    v_add_f32 v12, v12, v30
    v_mfma_f32_16x16x32_bf16 v[44:47], a[112:115], a[64:67], v[32:35]
    v_mfma_f32_16x16x32_bf16 v[44:47], a[116:119], a[68:71], v[44:47]
    v_mfma_f32_16x16x32_bf16 v[44:47], a[120:123], a[72:75], v[44:47]
    v_mfma_f32_16x16x32_bf16 v[44:47], a[124:127], a[76:79], v[44:47]
    v_mfma_f32_16x16x32_bf16 a[236:239], a[248:251], v[60:63], a[236:239]
    v_mfma_f32_16x16x32_bf16 v[160:163], a[192:195], v[60:63], v[160:163]
    s_nop 0
    v_exp_f32 v40, v40
    v_mfma_f32_16x16x32_bf16 v[164:167], a[196:199], v[60:63], v[164:167]
    v_exp_f32 v41, v41
    v_mfma_f32_16x16x32_bf16 v[168:171], a[200:203], v[60:63], v[168:171]
    v_exp_f32 v42, v42
    v_mfma_f32_16x16x32_bf16 v[172:175], a[204:207], v[60:63], v[172:175]
    v_accvgpr_read_b32 v28, a236
    v_add_f32 v28, v28, v12
    v_mfma_f32_16x16x32_bf16 v[176:179], a[208:211], v[60:63], v[176:179]
    v_add_f32 v15, v15, v28
    v_cvt_pk_bf16_f32 v56, v40, v41
    v_mfma_f32_16x16x32_bf16 v[180:183], a[212:215], v[60:63], v[180:183]
    v_rcp_f32 v28, v28
    v_mfma_f32_16x16x32_bf16 v[184:187], a[216:219], v[60:63], v[184:187]
    v_mul_f32 v29, s34, v28
    v_mfma_f32_16x16x32_bf16 v[188:191], a[220:223], v[60:63], v[188:191]
    v_exp_f32 v43, v43
    v_mfma_f32_16x16x32_bf16 v[48:51], a[128:131], a[64:67], v[32:35]
    v_exp_f32 v44, v44
    v_mfma_f32_16x16x32_bf16 v[48:51], a[132:135], a[68:71], v[48:51]
    v_exp_f32 v45, v45
    v_mfma_f32_16x16x32_bf16 v[48:51], a[136:139], a[72:75], v[48:51]
    v_exp_f32 v46, v46
    v_mfma_f32_16x16x32_bf16 v[48:51], a[140:143], a[76:79], v[48:51]
    v_exp_f32 v47, v47
    v_pk_fma_f32 v[160:161], v[160:161], v[28:29], v[28:29] op_sel:[0,0,1] op_sel_hi:[1,0,1] neg_lo:[0,0,1] neg_hi:[0,0,1]
    v_pk_fma_f32 v[162:163], v[162:163], v[28:29], v[28:29] op_sel:[0,0,1] op_sel_hi:[1,0,1] neg_lo:[0,0,1] neg_hi:[0,0,1]
    v_pk_fma_f32 v[164:165], v[164:165], v[28:29], v[28:29] op_sel:[0,0,1] op_sel_hi:[1,0,1] neg_lo:[0,0,1] neg_hi:[0,0,1]
    v_pk_fma_f32 v[166:167], v[166:167], v[28:29], v[28:29] op_sel:[0,0,1] op_sel_hi:[1,0,1] neg_lo:[0,0,1] neg_hi:[0,0,1]
    v_pk_fma_f32 v[168:169], v[168:169], v[28:29], v[28:29] op_sel:[0,0,1] op_sel_hi:[1,0,1] neg_lo:[0,0,1] neg_hi:[0,0,1]
    v_pk_fma_f32 v[170:171], v[170:171], v[28:29], v[28:29] op_sel:[0,0,1] op_sel_hi:[1,0,1] neg_lo:[0,0,1] neg_hi:[0,0,1]
    v_pk_fma_f32 v[172:173], v[172:173], v[28:29], v[28:29] op_sel:[0,0,1] op_sel_hi:[1,0,1] neg_lo:[0,0,1] neg_hi:[0,0,1]
    v_pk_fma_f32 v[174:175], v[174:175], v[28:29], v[28:29] op_sel:[0,0,1] op_sel_hi:[1,0,1] neg_lo:[0,0,1] neg_hi:[0,0,1]
    v_pk_fma_f32 v[176:177], v[176:177], v[28:29], v[28:29] op_sel:[0,0,1] op_sel_hi:[1,0,1] neg_lo:[0,0,1] neg_hi:[0,0,1]
    v_pk_fma_f32 v[178:179], v[178:179], v[28:29], v[28:29] op_sel:[0,0,1] op_sel_hi:[1,0,1] neg_lo:[0,0,1] neg_hi:[0,0,1]
    v_pk_fma_f32 v[180:181], v[180:181], v[28:29], v[28:29] op_sel:[0,0,1] op_sel_hi:[1,0,1] neg_lo:[0,0,1] neg_hi:[0,0,1]
    v_pk_fma_f32 v[182:183], v[182:183], v[28:29], v[28:29] op_sel:[0,0,1] op_sel_hi:[1,0,1] neg_lo:[0,0,1] neg_hi:[0,0,1]
    v_pk_fma_f32 v[184:185], v[184:185], v[28:29], v[28:29] op_sel:[0,0,1] op_sel_hi:[1,0,1] neg_lo:[0,0,1] neg_hi:[0,0,1]
    v_pk_fma_f32 v[186:187], v[186:187], v[28:29], v[28:29] op_sel:[0,0,1] op_sel_hi:[1,0,1] neg_lo:[0,0,1] neg_hi:[0,0,1]
    v_pk_fma_f32 v[188:189], v[188:189], v[28:29], v[28:29] op_sel:[0,0,1] op_sel_hi:[1,0,1] neg_lo:[0,0,1] neg_hi:[0,0,1]
    v_pk_fma_f32 v[190:191], v[190:191], v[28:29], v[28:29] op_sel:[0,0,1] op_sel_hi:[1,0,1] neg_lo:[0,0,1] neg_hi:[0,0,1]
    v_mfma_f32_16x16x32_bf16 v[52:55], a[144:147], a[64:67], v[32:35]
    v_cvt_pk_bf16_f32 v160, v160, v161
    v_cvt_pk_bf16_f32 v168, v168, v169
    v_mfma_f32_16x16x32_bf16 v[52:55], a[148:151], a[68:71], v[52:55]
    v_cvt_pk_bf16_f32 v161, v162, v163
    v_cvt_pk_bf16_f32 v169, v170, v171
    v_mfma_f32_16x16x32_bf16 v[52:55], a[152:155], a[72:75], v[52:55]
    v_cvt_pk_bf16_f32 v162, v164, v165
    v_cvt_pk_bf16_f32 v163, v166, v167
    v_mfma_f32_16x16x32_bf16 v[52:55], a[156:159], a[76:79], v[52:55]
    v_cvt_pk_bf16_f32 v170, v172, v173
    v_cvt_pk_bf16_f32 v171, v174, v175
    v_cvt_pk_bf16_f32 v57, v42, v43
    v_cvt_pk_bf16_f32 v58, v44, v45
    v_cvt_pk_bf16_f32 v59, v46, v47
    v_cndmask_b32_dpp v164, v168, v160, vcc quad_perm:[1,0,3,2] row_mask:0xf bank_mask:0xf
    v_cndmask_b32_dpp v166, v170, v162, vcc quad_perm:[1,0,3,2] row_mask:0xf bank_mask:0xf
    v_mfma_f32_16x16x32_bf16 a[240:243], a[248:251], v[56:59], a[240:243]
    v_cndmask_b32_dpp v165, v169, v161, vcc quad_perm:[1,0,3,2] row_mask:0xf bank_mask:0xf
    v_cndmask_b32_dpp v167, v171, v163, vcc quad_perm:[1,0,3,2] row_mask:0xf bank_mask:0xf
    v_mfma_f32_16x16x32_bf16 v[192:195], a[160:163], v[56:59], v[192:195]
    buffer_store_dwordx4 v[164:167], v3, s[16:19], s29 offen offset:0 sc0 sc1 nt
    v_mfma_f32_16x16x32_bf16 v[196:199], a[164:167], v[56:59], v[196:199]
    s_not_b64 vcc, vcc
    v_cndmask_b32_dpp v168, v160, v168, vcc quad_perm:[1,0,3,2] row_mask:0xf bank_mask:0xf
    v_cndmask_b32_dpp v169, v161, v169, vcc quad_perm:[1,0,3,2] row_mask:0xf bank_mask:0xf
    v_mfma_f32_16x16x32_bf16 v[200:203], a[168:171], v[56:59], v[200:203]
    v_cndmask_b32_dpp v170, v162, v170, vcc quad_perm:[1,0,3,2] row_mask:0xf bank_mask:0xf
    v_cndmask_b32_dpp v171, v163, v171, vcc quad_perm:[1,0,3,2] row_mask:0xf bank_mask:0xf
    v_mfma_f32_16x16x32_bf16 v[204:207], a[172:175], v[56:59], v[204:207]
    buffer_store_dwordx4 v[168:171], v3, s[16:19], s29 offen offset:256 sc0 sc1 nt
    v_mfma_f32_16x16x32_bf16 v[208:211], a[176:179], v[56:59], v[208:211]
    s_not_b64 vcc, vcc
    v_cvt_pk_bf16_f32 v176, v176, v177
    v_cvt_pk_bf16_f32 v184, v184, v185
    v_mfma_f32_16x16x32_bf16 v[212:215], a[180:183], v[56:59], v[212:215]
    v_cvt_pk_bf16_f32 v177, v178, v179
    v_cvt_pk_bf16_f32 v185, v186, v187
    v_mfma_f32_16x16x32_bf16 v[216:219], a[184:187], v[56:59], v[216:219]
    v_cvt_pk_bf16_f32 v178, v180, v181
    v_cvt_pk_bf16_f32 v179, v182, v183
    v_mfma_f32_16x16x32_bf16 v[220:223], a[188:191], v[56:59], v[220:223]
    v_cvt_pk_bf16_f32 v186, v188, v189
    v_cvt_pk_bf16_f32 v187, v190, v191
    v_cndmask_b32_dpp v180, v184, v176, vcc quad_perm:[1,0,3,2] row_mask:0xf bank_mask:0xf
    v_cndmask_b32_dpp v182, v186, v178, vcc quad_perm:[1,0,3,2] row_mask:0xf bank_mask:0xf
    v_exp_f32 v48, v48
    v_exp_f32 v49, v49
    v_cndmask_b32_dpp v181, v185, v177, vcc quad_perm:[1,0,3,2] row_mask:0xf bank_mask:0xf
    v_cndmask_b32_dpp v183, v187, v179, vcc quad_perm:[1,0,3,2] row_mask:0xf bank_mask:0xf
    buffer_store_dwordx4 v[180:183], v3, s[16:19], s29 offen offset:128 sc0 sc1 nt
    s_not_b64 vcc, vcc
    v_exp_f32 v50, v50
    v_exp_f32 v51, v51
    v_cndmask_b32_dpp v184, v176, v184, vcc quad_perm:[1,0,3,2] row_mask:0xf bank_mask:0xf
    v_cndmask_b32_dpp v185, v177, v185, vcc quad_perm:[1,0,3,2] row_mask:0xf bank_mask:0xf
    v_exp_f32 v52, v52
    v_exp_f32 v53, v53
    v_cndmask_b32_dpp v186, v178, v186, vcc quad_perm:[1,0,3,2] row_mask:0xf bank_mask:0xf
    v_cndmask_b32_dpp v187, v179, v187, vcc quad_perm:[1,0,3,2] row_mask:0xf bank_mask:0xf
    buffer_store_dwordx4 v[184:187], v3, s[16:19], s29 offen offset:384 sc0 sc1 nt
    s_not_b64 vcc, vcc
    s_add_u32 s29, s29, 4096
    v_mfma_f32_16x16x32_bf16 v[40:43], a[96:99], a[80:83], v[36:39]
    v_exp_f32 v54, v54
    v_mfma_f32_16x16x32_bf16 v[40:43], a[100:103], a[84:87], v[40:43]
    v_exp_f32 v55, v55
    v_mfma_f32_16x16x32_bf16 v[40:43], a[104:107], a[88:91], v[40:43]
    v_cvt_pk_bf16_f32 v60, v48, v49
    v_cvt_pk_bf16_f32 v61, v50, v51
    v_mfma_f32_16x16x32_bf16 v[40:43], a[108:111], a[92:95], v[40:43]
    v_cvt_pk_bf16_f32 v62, v52, v53
    v_cvt_pk_bf16_f32 v63, v54, v55
    v_mfma_f32_16x16x32_bf16 v[44:47], a[112:115], a[80:83], v[36:39]
    v_mov_b32 v34, v13
    v_mfma_f32_16x16x32_bf16 v[44:47], a[116:119], a[84:87], v[44:47]
    s_nop 0
    v_permlane32_swap_b32 v13, v34
    v_mfma_f32_16x16x32_bf16 v[44:47], a[120:123], a[88:91], v[44:47]
    v_add_f32 v13, v13, v34
    v_mov_b32 v34, v13
    v_mfma_f32_16x16x32_bf16 v[44:47], a[124:127], a[92:95], v[44:47]
    v_exp_f32 v40, v40
    v_mfma_f32_16x16x32_bf16 a[240:243], a[248:251], v[60:63], a[240:243]
    v_exp_f32 v41, v41
    v_mfma_f32_16x16x32_bf16 v[192:195], a[192:195], v[60:63], v[192:195]
    v_exp_f32 v42, v42
    v_mfma_f32_16x16x32_bf16 v[196:199], a[196:199], v[60:63], v[196:199]
    v_exp_f32 v43, v43
    v_mfma_f32_16x16x32_bf16 v[200:203], a[200:203], v[60:63], v[200:203]
    v_exp_f32 v44, v44
    v_mfma_f32_16x16x32_bf16 v[204:207], a[204:207], v[60:63], v[204:207]
    v_exp_f32 v45, v45
    v_mfma_f32_16x16x32_bf16 v[208:211], a[208:211], v[60:63], v[208:211]
    v_exp_f32 v46, v46
    v_mfma_f32_16x16x32_bf16 v[212:215], a[212:215], v[60:63], v[212:215]
    v_exp_f32 v47, v47
    v_mfma_f32_16x16x32_bf16 v[216:219], a[216:219], v[60:63], v[216:219]
    v_permlane16_swap_b32 v13, v34
    v_mfma_f32_16x16x32_bf16 v[220:223], a[220:223], v[60:63], v[220:223]
    v_cvt_pk_bf16_f32 v56, v40, v41
    v_cvt_pk_bf16_f32 v57, v42, v43
    v_mfma_f32_16x16x32_bf16 v[48:51], a[128:131], a[80:83], v[36:39]
    v_cvt_pk_bf16_f32 v58, v44, v45
    v_cvt_pk_bf16_f32 v59, v46, v47
    v_mfma_f32_16x16x32_bf16 v[48:51], a[132:135], a[84:87], v[48:51]
    v_add_f32 v13, v13, v34
    v_accvgpr_read_b32 v32, a240
    v_mfma_f32_16x16x32_bf16 v[48:51], a[136:139], a[88:91], v[48:51]
    v_add_f32 v32, v32, v13
    v_add_f32 v15, v15, v32
    v_mfma_f32_16x16x32_bf16 v[48:51], a[140:143], a[92:95], v[48:51]
    v_rcp_f32 v32, v32
    v_mfma_f32_16x16x32_bf16 v[52:55], a[144:147], a[80:83], v[36:39]
    v_mul_f32 v33, s34, v32
    v_mfma_f32_16x16x32_bf16 v[52:55], a[148:151], a[84:87], v[52:55]
    v_mfma_f32_16x16x32_bf16 v[52:55], a[152:155], a[88:91], v[52:55]
    v_mfma_f32_16x16x32_bf16 v[52:55], a[156:159], a[92:95], v[52:55]
    v_mfma_f32_16x16x32_bf16 a[244:247], a[248:251], v[56:59], a[244:247]
    s_nop 0
    v_exp_f32 v48, v48
    v_pk_fma_f32 v[192:193], v[192:193], v[32:33], v[32:33] op_sel:[0,0,1] op_sel_hi:[1,0,1] neg_lo:[0,0,1] neg_hi:[0,0,1]
    v_pk_fma_f32 v[194:195], v[194:195], v[32:33], v[32:33] op_sel:[0,0,1] op_sel_hi:[1,0,1] neg_lo:[0,0,1] neg_hi:[0,0,1]
    v_pk_fma_f32 v[196:197], v[196:197], v[32:33], v[32:33] op_sel:[0,0,1] op_sel_hi:[1,0,1] neg_lo:[0,0,1] neg_hi:[0,0,1]
    v_pk_fma_f32 v[198:199], v[198:199], v[32:33], v[32:33] op_sel:[0,0,1] op_sel_hi:[1,0,1] neg_lo:[0,0,1] neg_hi:[0,0,1]
    v_pk_fma_f32 v[200:201], v[200:201], v[32:33], v[32:33] op_sel:[0,0,1] op_sel_hi:[1,0,1] neg_lo:[0,0,1] neg_hi:[0,0,1]
    v_pk_fma_f32 v[202:203], v[202:203], v[32:33], v[32:33] op_sel:[0,0,1] op_sel_hi:[1,0,1] neg_lo:[0,0,1] neg_hi:[0,0,1]
    v_pk_fma_f32 v[204:205], v[204:205], v[32:33], v[32:33] op_sel:[0,0,1] op_sel_hi:[1,0,1] neg_lo:[0,0,1] neg_hi:[0,0,1]
    v_pk_fma_f32 v[206:207], v[206:207], v[32:33], v[32:33] op_sel:[0,0,1] op_sel_hi:[1,0,1] neg_lo:[0,0,1] neg_hi:[0,0,1]
    v_pk_fma_f32 v[208:209], v[208:209], v[32:33], v[32:33] op_sel:[0,0,1] op_sel_hi:[1,0,1] neg_lo:[0,0,1] neg_hi:[0,0,1]
    v_pk_fma_f32 v[210:211], v[210:211], v[32:33], v[32:33] op_sel:[0,0,1] op_sel_hi:[1,0,1] neg_lo:[0,0,1] neg_hi:[0,0,1]
    v_pk_fma_f32 v[212:213], v[212:213], v[32:33], v[32:33] op_sel:[0,0,1] op_sel_hi:[1,0,1] neg_lo:[0,0,1] neg_hi:[0,0,1]
    v_pk_fma_f32 v[214:215], v[214:215], v[32:33], v[32:33] op_sel:[0,0,1] op_sel_hi:[1,0,1] neg_lo:[0,0,1] neg_hi:[0,0,1]
    v_pk_fma_f32 v[216:217], v[216:217], v[32:33], v[32:33] op_sel:[0,0,1] op_sel_hi:[1,0,1] neg_lo:[0,0,1] neg_hi:[0,0,1]
    v_pk_fma_f32 v[218:219], v[218:219], v[32:33], v[32:33] op_sel:[0,0,1] op_sel_hi:[1,0,1] neg_lo:[0,0,1] neg_hi:[0,0,1]
    v_pk_fma_f32 v[220:221], v[220:221], v[32:33], v[32:33] op_sel:[0,0,1] op_sel_hi:[1,0,1] neg_lo:[0,0,1] neg_hi:[0,0,1]
    v_pk_fma_f32 v[222:223], v[222:223], v[32:33], v[32:33] op_sel:[0,0,1] op_sel_hi:[1,0,1] neg_lo:[0,0,1] neg_hi:[0,0,1]
    v_mfma_f32_16x16x32_bf16 v[224:227], a[160:163], v[56:59], v[224:227]
    v_cvt_pk_bf16_f32 v192, v192, v193
    v_cvt_pk_bf16_f32 v200, v200, v201
    v_mfma_f32_16x16x32_bf16 v[228:231], a[164:167], v[56:59], v[228:231]
    v_cvt_pk_bf16_f32 v193, v194, v195
    v_cvt_pk_bf16_f32 v201, v202, v203
    v_mfma_f32_16x16x32_bf16 v[232:235], a[168:171], v[56:59], v[232:235]
    v_cvt_pk_bf16_f32 v194, v196, v197
    v_cvt_pk_bf16_f32 v195, v198, v199
    v_mfma_f32_16x16x32_bf16 v[236:239], a[172:175], v[56:59], v[236:239]
    v_cvt_pk_bf16_f32 v202, v204, v205
    v_cvt_pk_bf16_f32 v203, v206, v207
    v_mfma_f32_16x16x32_bf16 v[240:243], a[176:179], v[56:59], v[240:243]
    v_cndmask_b32_dpp v196, v200, v192, vcc quad_perm:[1,0,3,2] row_mask:0xf bank_mask:0xf
    v_cndmask_b32_dpp v198, v202, v194, vcc quad_perm:[1,0,3,2] row_mask:0xf bank_mask:0xf
    v_mfma_f32_16x16x32_bf16 v[244:247], a[180:183], v[56:59], v[244:247]
    v_cndmask_b32_dpp v197, v201, v193, vcc quad_perm:[1,0,3,2] row_mask:0xf bank_mask:0xf
    v_cndmask_b32_dpp v199, v203, v195, vcc quad_perm:[1,0,3,2] row_mask:0xf bank_mask:0xf
    v_mfma_f32_16x16x32_bf16 v[248:251], a[184:187], v[56:59], v[248:251]
    buffer_store_dwordx4 v[196:199], v3, s[16:19], s29 offen offset:0 sc0 sc1 nt
    v_mfma_f32_16x16x32_bf16 v[252:255], a[188:191], v[56:59], v[252:255]
    s_not_b64 vcc, vcc
    v_exp_f32 v49, v49
    v_exp_f32 v50, v50
    v_exp_f32 v51, v51
    v_exp_f32 v52, v52
    v_exp_f32 v53, v53
    v_exp_f32 v54, v54
    v_exp_f32 v55, v55
    v_cvt_pk_bf16_f32 v60, v48, v49
    v_cvt_pk_bf16_f32 v61, v50, v51
    v_cvt_pk_bf16_f32 v62, v52, v53
    v_cvt_pk_bf16_f32 v63, v54, v55
    v_cndmask_b32_dpp v200, v192, v200, vcc quad_perm:[1,0,3,2] row_mask:0xf bank_mask:0xf
    v_cndmask_b32_dpp v201, v193, v201, vcc quad_perm:[1,0,3,2] row_mask:0xf bank_mask:0xf
    v_mfma_f32_16x16x32_bf16 a[244:247], a[248:251], v[60:63], a[244:247]
    v_cndmask_b32_dpp v202, v194, v202, vcc quad_perm:[1,0,3,2] row_mask:0xf bank_mask:0xf
    v_cndmask_b32_dpp v203, v195, v203, vcc quad_perm:[1,0,3,2] row_mask:0xf bank_mask:0xf
    v_mfma_f32_16x16x32_bf16 v[224:227], a[192:195], v[60:63], v[224:227]
    buffer_store_dwordx4 v[200:203], v3, s[16:19], s29 offen offset:256 sc0 sc1 nt
    v_mfma_f32_16x16x32_bf16 v[228:231], a[196:199], v[60:63], v[228:231]
    s_not_b64 vcc, vcc
    v_cvt_pk_bf16_f32 v208, v208, v209
    v_cvt_pk_bf16_f32 v216, v216, v217
    v_mfma_f32_16x16x32_bf16 v[232:235], a[200:203], v[60:63], v[232:235]
    v_cvt_pk_bf16_f32 v209, v210, v211
    v_cvt_pk_bf16_f32 v217, v218, v219
    v_mfma_f32_16x16x32_bf16 v[236:239], a[204:207], v[60:63], v[236:239]
    v_cvt_pk_bf16_f32 v210, v212, v213
    v_cvt_pk_bf16_f32 v211, v214, v215
    v_mfma_f32_16x16x32_bf16 v[240:243], a[208:211], v[60:63], v[240:243]
    v_cvt_pk_bf16_f32 v218, v220, v221
    v_cvt_pk_bf16_f32 v219, v222, v223
    v_mfma_f32_16x16x32_bf16 v[244:247], a[212:215], v[60:63], v[244:247]
    v_cndmask_b32_dpp v212, v216, v208, vcc quad_perm:[1,0,3,2] row_mask:0xf bank_mask:0xf
    v_cndmask_b32_dpp v214, v218, v210, vcc quad_perm:[1,0,3,2] row_mask:0xf bank_mask:0xf
    v_mfma_f32_16x16x32_bf16 v[248:251], a[216:219], v[60:63], v[248:251]
    v_cndmask_b32_dpp v213, v217, v209, vcc quad_perm:[1,0,3,2] row_mask:0xf bank_mask:0xf
    v_cndmask_b32_dpp v215, v219, v211, vcc quad_perm:[1,0,3,2] row_mask:0xf bank_mask:0xf
    v_mfma_f32_16x16x32_bf16 v[252:255], a[220:223], v[60:63], v[252:255]
    buffer_store_dwordx4 v[212:215], v3, s[16:19], s29 offen offset:128 sc0 sc1 nt
    v_accvgpr_read_b32 v36, a244
    s_not_b64 vcc, vcc
    v_add_f32 v15, v15, v36
    v_cndmask_b32_dpp v216, v208, v216, vcc quad_perm:[1,0,3,2] row_mask:0xf bank_mask:0xf
    v_cndmask_b32_dpp v217, v209, v217, vcc quad_perm:[1,0,3,2] row_mask:0xf bank_mask:0xf
    v_rcp_f32 v36, v36
    v_cndmask_b32_dpp v218, v210, v218, vcc quad_perm:[1,0,3,2] row_mask:0xf bank_mask:0xf
    v_mul_f32 v37, s34, v36
    v_cndmask_b32_dpp v219, v211, v219, vcc quad_perm:[1,0,3,2] row_mask:0xf bank_mask:0xf
    buffer_store_dwordx4 v[216:219], v3, s[16:19], s29 offen offset:384 sc0 sc1 nt
    v_fma_f32 v224, v224, v36, -v37
    v_fma_f32 v225, v225, v36, -v37
    v_pk_fma_f32 v[232:233], v[232:233], v[36:37], v[36:37] op_sel:[0,0,1] op_sel_hi:[1,0,1] neg_lo:[0,0,1] neg_hi:[0,0,1]
    v_fma_f32 v226, v226, v36, -v37
    v_fma_f32 v227, v227, v36, -v37
    v_cvt_pk_bf16_f32 v224, v224, v225
    v_pk_fma_f32 v[234:235], v[234:235], v[36:37], v[36:37] op_sel:[0,0,1] op_sel_hi:[1,0,1] neg_lo:[0,0,1] neg_hi:[0,0,1]
    v_cvt_pk_bf16_f32 v232, v232, v233
    v_fma_f32 v228, v228, v36, -v37
    v_fma_f32 v229, v229, v36, -v37
    v_fma_f32 v230, v230, v36, -v37
    v_fma_f32 v231, v231, v36, -v37
    v_cvt_pk_bf16_f32 v225, v226, v227
    v_pk_fma_f32 v[236:237], v[236:237], v[36:37], v[36:37] op_sel:[0,0,1] op_sel_hi:[1,0,1] neg_lo:[0,0,1] neg_hi:[0,0,1]
    v_pk_fma_f32 v[238:239], v[238:239], v[36:37], v[36:37] op_sel:[0,0,1] op_sel_hi:[1,0,1] neg_lo:[0,0,1] neg_hi:[0,0,1]
    v_cvt_pk_bf16_f32 v233, v234, v235
    v_cvt_pk_bf16_f32 v226, v228, v229
    v_cvt_pk_bf16_f32 v227, v230, v231
    v_cvt_pk_bf16_f32 v234, v236, v237
    v_cvt_pk_bf16_f32 v235, v238, v239
    s_not_b64 vcc, vcc
    s_add_u32 s29, s29, 4096
    v_cndmask_b32_dpp v228, v232, v224, vcc quad_perm:[1,0,3,2] row_mask:0xf bank_mask:0xf
    v_cndmask_b32_dpp v230, v234, v226, vcc quad_perm:[1,0,3,2] row_mask:0xf bank_mask:0xf
    v_pk_fma_f32 v[240:241], v[240:241], v[36:37], v[36:37] op_sel:[0,0,1] op_sel_hi:[1,0,1] neg_lo:[0,0,1] neg_hi:[0,0,1]
    v_pk_fma_f32 v[248:249], v[248:249], v[36:37], v[36:37] op_sel:[0,0,1] op_sel_hi:[1,0,1] neg_lo:[0,0,1] neg_hi:[0,0,1]
    v_cndmask_b32_dpp v229, v233, v225, vcc quad_perm:[1,0,3,2] row_mask:0xf bank_mask:0xf
    v_cndmask_b32_dpp v231, v235, v227, vcc quad_perm:[1,0,3,2] row_mask:0xf bank_mask:0xf
    buffer_store_dwordx4 v[228:231], v3, s[16:19], s29 offen offset:0 sc0 sc1 nt
    s_not_b64 vcc, vcc
    v_pk_fma_f32 v[242:243], v[242:243], v[36:37], v[36:37] op_sel:[0,0,1] op_sel_hi:[1,0,1] neg_lo:[0,0,1] neg_hi:[0,0,1]
    v_cvt_pk_bf16_f32 v240, v240, v241
    v_cndmask_b32_dpp v232, v224, v232, vcc quad_perm:[1,0,3,2] row_mask:0xf bank_mask:0xf
    v_cndmask_b32_dpp v233, v225, v233, vcc quad_perm:[1,0,3,2] row_mask:0xf bank_mask:0xf
    v_pk_fma_f32 v[250:251], v[250:251], v[36:37], v[36:37] op_sel:[0,0,1] op_sel_hi:[1,0,1] neg_lo:[0,0,1] neg_hi:[0,0,1]
    v_cvt_pk_bf16_f32 v248, v248, v249
    v_cndmask_b32_dpp v234, v226, v234, vcc quad_perm:[1,0,3,2] row_mask:0xf bank_mask:0xf
    v_cndmask_b32_dpp v235, v227, v235, vcc quad_perm:[1,0,3,2] row_mask:0xf bank_mask:0xf
    buffer_store_dwordx4 v[232:235], v3, s[16:19], s29 offen offset:256 sc0 sc1 nt
    v_pk_fma_f32 v[244:245], v[244:245], v[36:37], v[36:37] op_sel:[0,0,1] op_sel_hi:[1,0,1] neg_lo:[0,0,1] neg_hi:[0,0,1]
    v_pk_fma_f32 v[246:247], v[246:247], v[36:37], v[36:37] op_sel:[0,0,1] op_sel_hi:[1,0,1] neg_lo:[0,0,1] neg_hi:[0,0,1]
    v_cvt_pk_bf16_f32 v241, v242, v243
    v_pk_fma_f32 v[252:253], v[252:253], v[36:37], v[36:37] op_sel:[0,0,1] op_sel_hi:[1,0,1] neg_lo:[0,0,1] neg_hi:[0,0,1]
    v_pk_fma_f32 v[254:255], v[254:255], v[36:37], v[36:37] op_sel:[0,0,1] op_sel_hi:[1,0,1] neg_lo:[0,0,1] neg_hi:[0,0,1]
    v_cvt_pk_bf16_f32 v249, v250, v251
    v_cvt_pk_bf16_f32 v242, v244, v245
    v_cvt_pk_bf16_f32 v243, v246, v247
    v_cvt_pk_bf16_f32 v250, v252, v253
    v_cvt_pk_bf16_f32 v251, v254, v255
    s_not_b64 vcc, vcc
    v_cndmask_b32_dpp v244, v248, v240, vcc quad_perm:[1,0,3,2] row_mask:0xf bank_mask:0xf
    v_cndmask_b32_dpp v246, v250, v242, vcc quad_perm:[1,0,3,2] row_mask:0xf bank_mask:0xf
    v_cndmask_b32_dpp v245, v249, v241, vcc quad_perm:[1,0,3,2] row_mask:0xf bank_mask:0xf
    v_cndmask_b32_dpp v247, v251, v243, vcc quad_perm:[1,0,3,2] row_mask:0xf bank_mask:0xf
    buffer_store_dwordx4 v[244:247], v3, s[16:19], s29 offen offset:128 sc0 sc1 nt
    s_not_b64 vcc, vcc
    v_cndmask_b32_dpp v248, v240, v248, vcc quad_perm:[1,0,3,2] row_mask:0xf bank_mask:0xf
    v_cndmask_b32_dpp v249, v241, v249, vcc quad_perm:[1,0,3,2] row_mask:0xf bank_mask:0xf
    v_cndmask_b32_dpp v250, v242, v250, vcc quad_perm:[1,0,3,2] row_mask:0xf bank_mask:0xf
    v_cndmask_b32_dpp v251, v243, v251, vcc quad_perm:[1,0,3,2] row_mask:0xf bank_mask:0xf
    buffer_store_dwordx4 v[248:251], v3, s[16:19], s29 offen offset:384 sc0 sc1 nt
    s_not_b64 vcc, vcc
    s_add_u32 s29, s29, 4096
    s_lshl_b32 s26, s20, 13
    s_add_u32 s26, s26, 0x20000
    s_mov_b32 s27, 0x46000000
    v_cmp_ngt_f32 vcc, s27, v15
    s_cmp_lg_u64 vcc, 0
    s_cselect_b32 s27, 1, 0
    v_mbcnt_lo_u32_b32 v4, -1, 0
    v_mbcnt_hi_u32_b32 v4, -1, v4
    v_mov_b32 v5, s27
    v_mov_b32 v6, s26
    ds_write_b32 v6, v5 offset:6144
    v_and_b32 v6, 3, v4
    v_lshlrev_b32 v6, 13, v6
    v_add_u32 v6, 0x20000, v6
    s_waitcnt lgkmcnt(0)
    s_barrier
    ds_read_b32 v5, v6 offset:6144
    s_waitcnt lgkmcnt(0)
    v_cmp_ne_u32 vcc, 0, v5
    s_cmp_lg_u32 s25, 0
    s_cbranch_scc1 L_fin
    s_cbranch_vccz L_fin
    s_waitcnt vmcnt(0)
    s_barrier
    s_mov_b32 s25, 1
    v_and_b32 v6, 15, v4
    v_lshlrev_b32 v6, 8, v6
    v_lshrrev_b32 v5, 4, v4
    v_lshl_add_u32 v6, v5, 4, v6
    v_mov_b32 v128, 0xff800000
    v_mov_b32 v129, 0xff800000
    v_mov_b32 v130, 0xff800000
    v_mov_b32 v131, 0xff800000
    v_mov_b32 v132, 0xff800000
    v_mov_b32 v133, 0xff800000
    s_mov_b32 s26, 0
L_max6:
    buffer_load_dwordx4 a[96:99], v6, s[8:11], s26 offen offset:0
    buffer_load_dwordx4 a[100:103], v6, s[8:11], s26 offen offset:64
    buffer_load_dwordx4 a[104:107], v6, s[8:11], s26 offen offset:128
    buffer_load_dwordx4 a[108:111], v6, s[8:11], s26 offen offset:192
    s_waitcnt vmcnt(0)
    v_mfma_f32_16x16x32_bf16 v[64:67], a[96:99], a[0:3], 0
    v_mfma_f32_16x16x32_bf16 v[64:67], a[100:103], a[4:7], v[64:67]
    v_mfma_f32_16x16x32_bf16 v[64:67], a[104:107], a[8:11], v[64:67]
    v_mfma_f32_16x16x32_bf16 v[64:67], a[108:111], a[12:15], v[64:67]
    v_mfma_f32_16x16x32_bf16 v[68:71], a[96:99], a[16:19], 0
    v_mfma_f32_16x16x32_bf16 v[68:71], a[100:103], a[20:23], v[68:71]
    v_mfma_f32_16x16x32_bf16 v[68:71], a[104:107], a[24:27], v[68:71]
    v_mfma_f32_16x16x32_bf16 v[68:71], a[108:111], a[28:31], v[68:71]
    v_mfma_f32_16x16x32_bf16 v[72:75], a[96:99], a[32:35], 0
    v_mfma_f32_16x16x32_bf16 v[72:75], a[100:103], a[36:39], v[72:75]
    v_mfma_f32_16x16x32_bf16 v[72:75], a[104:107], a[40:43], v[72:75]
    v_mfma_f32_16x16x32_bf16 v[72:75], a[108:111], a[44:47], v[72:75]
    v_mfma_f32_16x16x32_bf16 v[76:79], a[96:99], a[48:51], 0
    v_mfma_f32_16x16x32_bf16 v[76:79], a[100:103], a[52:55], v[76:79]
    v_mfma_f32_16x16x32_bf16 v[76:79], a[104:107], a[56:59], v[76:79]
    v_mfma_f32_16x16x32_bf16 v[76:79], a[108:111], a[60:63], v[76:79]
    v_mfma_f32_16x16x32_bf16 v[80:83], a[96:99], a[64:67], 0
    v_mfma_f32_16x16x32_bf16 v[80:83], a[100:103], a[68:71], v[80:83]
    v_mfma_f32_16x16x32_bf16 v[80:83], a[104:107], a[72:75], v[80:83]
    v_mfma_f32_16x16x32_bf16 v[80:83], a[108:111], a[76:79], v[80:83]
    v_mfma_f32_16x16x32_bf16 v[84:87], a[96:99], a[80:83], 0
    v_mfma_f32_16x16x32_bf16 v[84:87], a[100:103], a[84:87], v[84:87]
    v_mfma_f32_16x16x32_bf16 v[84:87], a[104:107], a[88:91], v[84:87]
    v_mfma_f32_16x16x32_bf16 v[84:87], a[108:111], a[92:95], v[84:87]
    s_nop 7
    v_max3_f32 v128, v128, v64, v65
    v_max3_f32 v128, v128, v66, v67
    v_max3_f32 v129, v129, v68, v69
    v_max3_f32 v129, v129, v70, v71
    v_max3_f32 v130, v130, v72, v73
    v_max3_f32 v130, v130, v74, v75
    v_max3_f32 v131, v131, v76, v77
    v_max3_f32 v131, v131, v78, v79
    v_max3_f32 v132, v132, v80, v81
    v_max3_f32 v132, v132, v82, v83
    v_max3_f32 v133, v133, v84, v85
    v_max3_f32 v133, v133, v86, v87
    s_add_u32 s26, s26, 4096
    s_cmp_lt_u32 s26, 0x40000
    s_cbranch_scc1 L_max6
    v_mov_b32 v5, v128
    s_nop 1
    v_permlane32_swap_b32 v128, v5
    v_max_f32 v128, v128, v5
    v_mov_b32 v5, v128
    s_nop 1
    v_permlane16_swap_b32 v128, v5
    v_max_f32 v128, v128, v5
    v_sub_f32 v16, 0, v128
    v_mov_b32 v5, v129
    s_nop 1
    v_permlane32_swap_b32 v129, v5
    v_max_f32 v129, v129, v5
    v_mov_b32 v5, v129
    s_nop 1
    v_permlane16_swap_b32 v129, v5
    v_max_f32 v129, v129, v5
    v_sub_f32 v20, 0, v129
    v_mov_b32 v5, v130
    s_nop 1
    v_permlane32_swap_b32 v130, v5
    v_max_f32 v130, v130, v5
    v_mov_b32 v5, v130
    s_nop 1
    v_permlane16_swap_b32 v130, v5
    v_max_f32 v130, v130, v5
    v_sub_f32 v24, 0, v130
    v_mov_b32 v5, v131
    s_nop 1
    v_permlane32_swap_b32 v131, v5
    v_max_f32 v131, v131, v5
    v_mov_b32 v5, v131
    s_nop 1
    v_permlane16_swap_b32 v131, v5
    v_max_f32 v131, v131, v5
    v_sub_f32 v28, 0, v131
    v_mov_b32 v5, v132
    s_nop 1
    v_permlane32_swap_b32 v132, v5
    v_max_f32 v132, v132, v5
    v_mov_b32 v5, v132
    s_nop 1
    v_permlane16_swap_b32 v132, v5
    v_max_f32 v132, v132, v5
    v_sub_f32 v32, 0, v132
    v_mov_b32 v5, v133
    s_nop 1
    v_permlane32_swap_b32 v133, v5
    v_max_f32 v133, v133, v5
    v_mov_b32 v5, v133
    s_nop 1
    v_permlane16_swap_b32 v133, v5
    v_max_f32 v133, v133, v5
    v_sub_f32 v36, 0, v133
    v_mbcnt_lo_u32_b32 v0, -1, 0
    v_mbcnt_hi_u32_b32 v0, -1, v0
    s_and_b32 s26, s20, 1
    s_lshl_b32 s23, s26, 5
    v_lshrrev_b32 v1, 4, v0
    v_lshlrev_b32 v3, 2, v1
    v_xor_b32 v3, v3, v0
    v_and_b32 v3, 15, v3
    v_lshlrev_b32 v3, 4, v3
    v_lshl_add_u32 v3, v1, 8, v3
    v_xor_b32 v3, s23, v3
    v_xor_b32 v234, 32, v3
    s_and_b32 s27, s20, 2
    s_lshl1_add_u32 s26, s27, s26
    s_lshl_b32 s26, s26, 10
    s_add_u32 s27, s26, 8192
    s_add_u32 s21, s26, 16384
    s_mul_i32 s29, s20, 24576
    s_lshl_b32 s28, s20, 12
    s_add_u32 m0, s28, 0x8000
    s_nop 0
    buffer_load_dwordx4 v3, s[4:7], s29 offen offset:0 nt lds
    buffer_load_dwordx4 v234, s[4:7], s29 offen offset:1024 nt lds
    buffer_load_dwordx4 v3, s[4:7], s29 offen offset:2048 nt lds
    buffer_load_dwordx4 v234, s[4:7], s29 offen offset:3072 nt lds
    s_add_u32 s29, s29, 4096
    s_add_u32 m0, s26, 0x0
    s_nop 0
    buffer_load_dwordx4 v3, s[8:11], s26 offen nt lds
    buffer_load_dwordx4 v3, s[8:11], s26 offen offset:2048 nt lds
    s_add_u32 m0, s27, 0x0
    s_nop 0
    buffer_load_dwordx4 v3, s[8:11], s27 offen nt lds
    buffer_load_dwordx4 v3, s[8:11], s27 offen offset:2048 nt lds
    s_branch L_restart
L_pro5:
    s_waitcnt lgkmcnt(15)
    v_mfma_f32_16x16x32_bf16 v[40:43], a[96:99], a[0:3], 0
    s_add_u32 m0, s28, 0x1c000
    v_mbcnt_lo_u32_b32 v14, -1, 0
    v_mbcnt_hi_u32_b32 v14, -1, v14
    s_waitcnt lgkmcnt(14)
    v_mfma_f32_16x16x32_bf16 v[40:43], a[100:103], a[4:7], v[40:43]
    s_mov_b32 s23, 0x4000
    v_lshrrev_b32 v13, 4, v14
    v_mul_u32_u24 v13, 20, v13
    s_waitcnt lgkmcnt(11)
    v_mfma_f32_16x16x32_bf16 v[40:43], a[104:107], a[8:11], v[40:43]
    s_mov_b32 s22, 14
    v_sub_u32 v14, v14, v13
    v_cmp_eq_u32 vcc, 0, v14
    v_mfma_f32_16x16x32_bf16 v[40:43], a[108:111], a[12:15], v[40:43]
    v_mov_b32 v12, 0x71800000
    v_mov_b32 v2, 0
    v_mfma_f32_16x16x32_bf16 v[44:47], a[112:115], a[0:3], 0
    s_waitcnt lgkmcnt(2)
    v_mfma_f32_16x16x32_bf16 v[44:47], a[116:119], a[4:7], v[44:47]
    v_mfma_f32_16x16x32_bf16 v[44:47], a[120:123], a[8:11], v[44:47]
    v_mfma_f32_16x16x32_bf16 v[44:47], a[124:127], a[12:15], v[44:47]
    s_nop 0
    v_max3_f32 v0, v40, v41, v42
    s_nop 5
    v_max3_f32 v1, v43, v44, v45
    v_max3_f32 v0, v0, v46, v47
    v_max_f32 v0, v0, v1
    v_mov_b32 v1, v0
    s_nop 1
    v_permlane32_swap_b32 v0, v1
    v_max_f32 v0, v0, v1
    v_mov_b32 v1, v0
    s_nop 1
    v_permlane16_swap_b32 v0, v1
    v_max_f32 v0, v0, v1
    v_min_f32 v16, -v0, v16
    v_add_f32 v16, 0xc1300000, v16
    v_mov_b32 v17, v16
    v_mov_b32 v18, v16
    v_mov_b32 v19, v16
    v_add_f32 v40, v40, v16
    v_add_f32 v41, v41, v16
    v_mfma_f32_16x16x32_bf16 v[48:51], a[128:131], a[0:3], v[16:19]
    v_add_f32 v42, v42, v16
    v_add_f32 v43, v43, v16
    v_mfma_f32_16x16x32_bf16 v[48:51], a[132:135], a[4:7], v[48:51]
    v_add_f32 v44, v44, v16
    v_add_f32 v45, v45, v16
    v_mfma_f32_16x16x32_bf16 v[48:51], a[136:139], a[8:11], v[48:51]
    v_add_f32 v46, v46, v16
    v_add_f32 v47, v47, v16
    v_mfma_f32_16x16x32_bf16 v[48:51], a[140:143], a[12:15], v[48:51]
    v_exp_f32 v40, v40
    v_mfma_f32_16x16x32_bf16 v[52:55], a[144:147], a[0:3], v[16:19]
    v_exp_f32 v41, v41
    v_mfma_f32_16x16x32_bf16 v[52:55], a[148:151], a[4:7], v[52:55]
    v_exp_f32 v42, v42
    s_waitcnt lgkmcnt(0)
    v_mfma_f32_16x16x32_bf16 v[52:55], a[152:155], a[8:11], v[52:55]
    v_exp_f32 v43, v43
    v_mfma_f32_16x16x32_bf16 v[52:55], a[156:159], a[12:15], v[52:55]
    s_waitcnt vmcnt(8)
    buffer_load_dwordx4 v3, s[4:7], s29 offen offset:0 nt lds
    buffer_load_dwordx4 v234, s[4:7], s29 offen offset:1024 nt lds
    buffer_load_dwordx4 v3, s[4:7], s29 offen offset:2048 nt lds
    buffer_load_dwordx4 v234, s[4:7], s29 offen offset:3072 nt lds
    s_barrier
    ds_read_b64_tr_b16 a[160:161], v8 offset:0
    ds_read_b64_tr_b16 a[162:163], v8 offset:4096
    ds_read_b64_tr_b16 a[164:165], v8 offset:8
    ds_read_b64_tr_b16 a[166:167], v8 offset:4104
    ds_read_b64_tr_b16 a[168:169], v9 offset:0
    ds_read_b64_tr_b16 a[170:171], v9 offset:4096
    ds_read_b64_tr_b16 a[172:173], v9 offset:8
    ds_read_b64_tr_b16 a[174:175], v9 offset:4104
    ds_read_b64_tr_b16 a[176:177], v10 offset:0
    ds_read_b64_tr_b16 a[178:179], v10 offset:4096
    ds_read_b64_tr_b16 a[180:181], v10 offset:8
    ds_read_b64_tr_b16 a[182:183], v10 offset:4104
    ds_read_b64_tr_b16 a[184:185], v11 offset:0
    ds_read_b64_tr_b16 a[186:187], v11 offset:4096
    ds_read_b64_tr_b16 a[188:189], v11 offset:8
    ds_read_b64_tr_b16 a[190:191], v11 offset:4104
    v_exp_f32 v44, v44
    s_waitcnt lgkmcnt(14)
    v_mfma_f32_16x16x32_bf16 v[192:195], a[160:163], a[160:163], 0
    ds_read_b64_tr_b16 a[192:193], v8 offset:8192
    v_cvt_pk_bf16_f32 v56, v40, v41
    s_waitcnt lgkmcnt(13)
    v_mfma_f32_16x16x32_bf16 v[196:199], a[164:167], a[164:167], 0
    ds_read_b64_tr_b16 a[194:195], v8 offset:12288
    v_cvt_pk_bf16_f32 v57, v42, v43
    s_waitcnt lgkmcnt(12)
    v_mfma_f32_16x16x32_bf16 v[200:203], a[168:171], a[168:171], 0
    ds_read_b64_tr_b16 a[196:197], v8 offset:8200
    s_waitcnt lgkmcnt(11)
    v_mfma_f32_16x16x32_bf16 v[204:207], a[172:175], a[172:175], 0
    ds_read_b64_tr_b16 a[198:199], v8 offset:12296
    s_waitcnt lgkmcnt(10)
    v_mfma_f32_16x16x32_bf16 v[208:211], a[176:179], a[176:179], 0
    ds_read_b64_tr_b16 a[200:201], v9 offset:8192
    s_waitcnt lgkmcnt(9)
    v_mfma_f32_16x16x32_bf16 v[212:215], a[180:183], a[180:183], 0
    ds_read_b64_tr_b16 a[202:203], v9 offset:12288
    s_waitcnt lgkmcnt(8)
    v_mfma_f32_16x16x32_bf16 v[216:219], a[184:187], a[184:187], 0
    ds_read_b64_tr_b16 a[204:205], v9 offset:8200
    v_min3_f32 v192, v192, v196, v200
    s_waitcnt lgkmcnt(7)
    v_mfma_f32_16x16x32_bf16 v[220:223], a[188:191], a[188:191], 0
    ds_read_b64_tr_b16 a[206:207], v9 offset:12296
    ds_read_b64_tr_b16 a[208:209], v10 offset:8192
    ds_read_b64_tr_b16 a[210:211], v10 offset:12288
    ds_read_b64_tr_b16 a[212:213], v10 offset:8200
    ds_read_b64_tr_b16 a[214:215], v10 offset:12296
    ds_read_b64_tr_b16 a[216:217], v11 offset:8192
    ds_read_b64_tr_b16 a[218:219], v11 offset:12288
    ds_read_b64_tr_b16 a[220:221], v11 offset:8200
    ds_read_b64_tr_b16 a[222:223], v11 offset:12296
    s_waitcnt vmcnt(8)
    ds_read_b128 a[16:19], v236 offset:49152
    s_add_u32 s29, s29, 4096
    ds_read_b128 a[20:23], v237 offset:49152
    ds_read_b128 a[24:27], v238 offset:49152
    s_add_u32 m0, s28, 0x20000
    ds_read_b128 a[28:31], v239 offset:49152
    buffer_load_dwordx4 v3, s[4:7], s29 offen offset:0 nt lds
    buffer_load_dwordx4 v234, s[4:7], s29 offen offset:1024 nt lds
    buffer_load_dwordx4 v3, s[4:7], s29 offen offset:2048 nt lds
    buffer_load_dwordx4 v234, s[4:7], s29 offen offset:3072 nt lds
    s_add_u32 s29, s29, 4096
    s_cmp_lg_u32 s25, 0
    s_cselect_b32 s34, 0, 0x3fc00000
    s_and_b32 m0, s21, 0xffff
    v_min3_f32 v193, v193, v197, v201
    v_min3_f32 v194, v194, v198, v202
    v_min3_f32 v195, v195, v199, v203
    v_min3_f32 v204, v204, v208, v212
    v_min3_f32 v192, v192, v216, v220
    v_min3_f32 v205, v205, v209, v213
    v_min3_f32 v193, v193, v217, v221
    v_min3_f32 v206, v206, v210, v214
    v_min3_f32 v194, v194, v218, v222
    v_min3_f32 v207, v207, v211, v215
    v_min3_f32 v195, v195, v219, v223
    v_min3_f32 v192, v192, v204, v12
    v_min3_f32 v193, v193, v205, v12
    v_min3_f32 v194, v194, v206, v12
    v_min3_f32 v195, v195, v207, v12
    v_cndmask_b32 v12, v12, v192, vcc
    v_cmp_eq_u32 vcc, 1, v14
    v_exp_f32 v45, v45
    v_exp_f32 v46, v46
    v_cndmask_b32 v12, v12, v193, vcc
    v_cmp_eq_u32 vcc, 2, v14
    v_exp_f32 v47, v47
    v_cvt_pk_bf16_f32 v58, v44, v45
    v_cndmask_b32 v12, v12, v194, vcc
    v_cmp_eq_u32 vcc, 3, v14
    v_cvt_pk_bf16_f32 v59, v46, v47
    v_exp_f32 v48, v48
    v_cndmask_b32 v12, v12, v195, vcc
    v_mov_b32 v13, v12
    v_exp_f32 v49, v49
    v_exp_f32 v50, v50
    v_permlane32_swap_b32 v12, v13
    v_min_f32 v12, v12, v13
    v_mov_b32 v13, v12
    v_exp_f32 v51, v51
    v_exp_f32 v52, v52
    v_permlane16_swap_b32 v12, v13
    v_min_f32 v12, v12, v13
    v_exp_f32 v53, v53
    v_exp_f32 v54, v54
    v_min_f32_dpp v12, v12, v12 row_ror:8 row_mask:0xf bank_mask:0xf
    v_exp_f32 v55, v55
    v_cvt_pk_bf16_f32 v60, v48, v49
    v_min_f32_dpp v12, v12, v12 row_ror:4 row_mask:0xf bank_mask:0xf
    v_cvt_pk_bf16_f32 v61, v50, v51
    v_cvt_pk_bf16_f32 v62, v52, v53
    v_min_f32_dpp v12, v12, v12 row_ror:2 row_mask:0xf bank_mask:0xf
    v_cvt_pk_bf16_f32 v63, v54, v55
    v_add_u32 v236, 0x18000, v236
    v_min_f32_dpp v12, v12, v12 row_ror:1 row_mask:0xf bank_mask:0xf
    v_mul_f32 v12, 0x39000000, v12
    v_sqrt_f32 v12, v12
    v_add_u32 v237, 0x18000, v237
    v_and_b32 v12, 0x7f800000, v12
    v_mul_f32 v12, s34, v12
    v_mov_b32 v13, v12
    v_mov_b32 v14, v12
    v_mov_b32 v15, v12
    v_add_u32 v238, 0x18000, v238
    v_add_u32 v239, 0x18000, v239
    v_mfma_f32_16x16x32_bf16 v[64:67], a[160:163], v[56:59], v[12:15]
    v_readfirstlane_b32 s34, v12
    v_mfma_f32_16x16x32_bf16 v[68:71], a[164:167], v[56:59], v[12:15]
    v_mfma_f32_16x16x32_bf16 v[72:75], a[168:171], v[56:59], v[12:15]
    v_mfma_f32_16x16x32_bf16 v[76:79], a[172:175], v[56:59], v[12:15]
    v_mfma_f32_16x16x32_bf16 v[80:83], a[176:179], v[56:59], v[12:15]
    v_mfma_f32_16x16x32_bf16 v[84:87], a[180:183], v[56:59], v[12:15]
    v_mfma_f32_16x16x32_bf16 v[88:91], a[184:187], v[56:59], v[12:15]
    v_mfma_f32_16x16x32_bf16 v[92:95], a[188:191], v[56:59], v[12:15]
    v_mfma_f32_16x16x32_bf16 a[224:227], a[248:251], v[56:59], 0
    s_waitcnt lgkmcnt(0)
    v_mfma_f32_16x16x32_bf16 v[240:243], v[226:229], a[16:19], 0
    v_mfma_f32_16x16x32_bf16 v[240:243], v[230:233], a[16:19], v[240:243]
    v_mfma_f32_16x16x32_bf16 v[244:247], v[224:227], a[16:19], 0
    v_mfma_f32_16x16x32_bf16 v[244:247], v[228:231], a[16:19], v[244:247]
    v_mfma_f32_16x16x32_bf16 v[248:251], v[226:229], a[20:23], 0
    v_mfma_f32_16x16x32_bf16 v[248:251], v[230:233], a[20:23], v[248:251]
    v_mfma_f32_16x16x32_bf16 v[252:255], v[224:227], a[20:23], 0
    v_mfma_f32_16x16x32_bf16 v[252:255], v[228:231], a[20:23], v[252:255]
    s_nop 1
    v_cvt_pk_bf16_f32 v240, v240, v241
    v_cvt_pk_bf16_f32 v242, v242, v243
    v_accvgpr_write_b32 a16, v240
    v_accvgpr_write_b32 a17, v242
    v_mfma_f32_16x16x32_bf16 v[240:243], v[226:229], a[24:27], 0
    v_cvt_pk_bf16_f32 v244, v244, v245
    v_cvt_pk_bf16_f32 v246, v246, v247
    v_mfma_f32_16x16x32_bf16 v[240:243], v[230:233], a[24:27], v[240:243]
    v_accvgpr_write_b32 a18, v244
    v_accvgpr_write_b32 a19, v246
    v_mfma_f32_16x16x32_bf16 v[244:247], v[224:227], a[24:27], 0
    v_cvt_pk_bf16_f32 v248, v248, v249
    v_cvt_pk_bf16_f32 v250, v250, v251
    v_mfma_f32_16x16x32_bf16 v[244:247], v[228:231], a[24:27], v[244:247]
    v_accvgpr_write_b32 a20, v248
    v_accvgpr_write_b32 a21, v250
    v_mfma_f32_16x16x32_bf16 v[248:251], v[226:229], a[28:31], 0
    v_cvt_pk_bf16_f32 v252, v252, v253
    v_cvt_pk_bf16_f32 v254, v254, v255
    v_mfma_f32_16x16x32_bf16 v[248:251], v[230:233], a[28:31], v[248:251]
    v_accvgpr_write_b32 a22, v252
    v_accvgpr_write_b32 a23, v254
    v_mfma_f32_16x16x32_bf16 v[252:255], v[224:227], a[28:31], 0
    v_cvt_pk_bf16_f32 v240, v240, v241
    v_cvt_pk_bf16_f32 v242, v242, v243
    v_mfma_f32_16x16x32_bf16 v[252:255], v[228:231], a[28:31], v[252:255]
    v_cvt_pk_bf16_f32 v244, v244, v245
    v_cvt_pk_bf16_f32 v246, v246, v247
    v_mfma_f32_16x16x32_bf16 v[40:43], a[96:99], a[16:19], 0
    v_accvgpr_write_b32 a24, v240
    v_accvgpr_write_b32 a25, v242
    v_mfma_f32_16x16x32_bf16 v[40:43], a[100:103], a[20:23], v[40:43]
    v_accvgpr_write_b32 a26, v244
    v_accvgpr_write_b32 a27, v246
    v_cvt_pk_bf16_f32 v248, v248, v249
    v_cvt_pk_bf16_f32 v250, v250, v251
    v_mfma_f32_16x16x32_bf16 v[40:43], a[104:107], a[24:27], v[40:43]
    v_cvt_pk_bf16_f32 v252, v252, v253
    v_cvt_pk_bf16_f32 v254, v254, v255
    v_accvgpr_write_b32 a28, v248
    v_accvgpr_write_b32 a29, v250
    v_accvgpr_write_b32 a30, v252
    v_accvgpr_write_b32 a31, v254
    s_nop 1
    v_mfma_f32_16x16x32_bf16 v[40:43], a[108:111], a[28:31], v[40:43]
    v_mfma_f32_16x16x32_bf16 v[44:47], a[112:115], a[16:19], 0
    v_mfma_f32_16x16x32_bf16 v[44:47], a[116:119], a[20:23], v[44:47]
    v_mfma_f32_16x16x32_bf16 v[44:47], a[120:123], a[24:27], v[44:47]
    v_mfma_f32_16x16x32_bf16 v[44:47], a[124:127], a[28:31], v[44:47]
    s_waitcnt vmcnt(8)
    ds_read_b128 a[32:35], v236 offset:0
    v_mfma_f32_16x16x32_bf16 v[64:67], a[192:195], v[60:63], v[64:67]
    ds_read_b128 a[36:39], v237 offset:0
    v_max3_f32 v0, v40, v41, v42
    v_mfma_f32_16x16x32_bf16 v[68:71], a[196:199], v[60:63], v[68:71]
    ds_read_b128 a[40:43], v238 offset:0
    ds_read_b128 a[44:47], v239 offset:0
    v_mfma_f32_16x16x32_bf16 v[72:75], a[200:203], v[60:63], v[72:75]
    buffer_load_dwordx4 v3, s[8:11], s21 offen nt lds
    v_mfma_f32_16x16x32_bf16 v[76:79], a[204:207], v[60:63], v[76:79]
    buffer_load_dwordx4 v3, s[8:11], s21 offen offset:2048 nt lds
    v_mfma_f32_16x16x32_bf16 v[80:83], a[208:211], v[60:63], v[80:83]
    s_bitset1_b32 m0, 16
    v_max3_f32 v1, v43, v44, v45
    v_max3_f32 v0, v0, v46, v47
    v_mfma_f32_16x16x32_bf16 v[84:87], a[212:215], v[60:63], v[84:87]
    buffer_load_dwordx4 v3, s[12:15], s21 offen nt lds
    v_mfma_f32_16x16x32_bf16 v[88:91], a[216:219], v[60:63], v[88:91]
    buffer_load_dwordx4 v3, s[12:15], s21 offen offset:2048 nt lds
    v_mfma_f32_16x16x32_bf16 v[92:95], a[220:223], v[60:63], v[92:95]
    s_add_u32 s21, s21, 8192
    v_max_f32 v0, v0, v1
    v_mov_b32 v1, v0
    v_mfma_f32_16x16x32_bf16 a[224:227], a[248:251], v[60:63], a[224:227]
    s_and_b32 m0, s21, 0xffff
    v_permlane32_swap_b32 v0, v1
    s_waitcnt lgkmcnt(2)
    v_mfma_f32_16x16x32_bf16 v[240:243], v[226:229], a[32:35], 0
    v_max_f32 v0, v0, v1
    v_mov_b32 v1, v0
    v_mfma_f32_16x16x32_bf16 v[240:243], v[230:233], a[32:35], v[240:243]
    s_nop 0
    v_permlane16_swap_b32 v0, v1
    v_mfma_f32_16x16x32_bf16 v[244:247], v[224:227], a[32:35], 0
    v_max_f32 v0, v0, v1
    v_min_f32 v20, -v0, v20
    v_mfma_f32_16x16x32_bf16 v[244:247], v[228:231], a[32:35], v[244:247]
    v_add_f32 v20, 0xc1300000, v20
    v_mov_b32 v21, v20
    v_mov_b32 v22, v20
    v_mov_b32 v23, v20
    v_cvt_pk_bf16_f32 v240, v240, v241
    v_cvt_pk_bf16_f32 v242, v242, v243
    v_mfma_f32_16x16x32_bf16 v[48:51], a[128:131], a[16:19], v[20:23]
    v_accvgpr_write_b32 a32, v240
    v_accvgpr_write_b32 a33, v242
    v_mfma_f32_16x16x32_bf16 v[48:51], a[132:135], a[20:23], v[48:51]
    v_cvt_pk_bf16_f32 v244, v244, v245
    v_cvt_pk_bf16_f32 v246, v246, v247
    v_mfma_f32_16x16x32_bf16 v[48:51], a[136:139], a[24:27], v[48:51]
    v_accvgpr_write_b32 a34, v244
    v_accvgpr_write_b32 a35, v246
    v_mfma_f32_16x16x32_bf16 v[48:51], a[140:143], a[28:31], v[48:51]
    v_add_f32 v40, v40, v20
    v_add_f32 v41, v41, v20
    v_mfma_f32_16x16x32_bf16 v[52:55], a[144:147], a[16:19], v[20:23]
    v_add_f32 v42, v42, v20
    v_add_f32 v43, v43, v20
    v_mfma_f32_16x16x32_bf16 v[52:55], a[148:151], a[20:23], v[52:55]
    v_add_f32 v44, v44, v20
    v_add_f32 v45, v45, v20
    v_mfma_f32_16x16x32_bf16 v[52:55], a[152:155], a[24:27], v[52:55]
    v_add_f32 v46, v46, v20
    v_add_f32 v47, v47, v20
    v_mfma_f32_16x16x32_bf16 v[52:55], a[156:159], a[28:31], v[52:55]
    v_exp_f32 v40, v40
    v_mfma_f32_16x16x32_bf16 v[248:251], v[226:229], a[36:39], 0
    v_exp_f32 v41, v41
    v_mfma_f32_16x16x32_bf16 v[248:251], v[230:233], a[36:39], v[248:251]
    v_exp_f32 v42, v42
    v_mfma_f32_16x16x32_bf16 v[252:255], v[224:227], a[36:39], 0
    v_exp_f32 v43, v43
    v_mfma_f32_16x16x32_bf16 v[252:255], v[228:231], a[36:39], v[252:255]
    v_exp_f32 v44, v44
    s_waitcnt lgkmcnt(0)
    v_mfma_f32_16x16x32_bf16 v[240:243], v[226:229], a[40:43], 0
    v_exp_f32 v45, v45
    v_mfma_f32_16x16x32_bf16 v[240:243], v[230:233], a[40:43], v[240:243]
    v_cvt_pk_bf16_f32 v248, v248, v249
    v_cvt_pk_bf16_f32 v250, v250, v251
    v_mfma_f32_16x16x32_bf16 v[244:247], v[224:227], a[40:43], 0
    v_accvgpr_write_b32 a36, v248
    v_accvgpr_write_b32 a37, v250
    v_mfma_f32_16x16x32_bf16 v[244:247], v[228:231], a[40:43], v[244:247]
    v_cvt_pk_bf16_f32 v252, v252, v253
    v_cvt_pk_bf16_f32 v254, v254, v255
    v_mfma_f32_16x16x32_bf16 v[248:251], v[226:229], a[44:47], 0
    v_accvgpr_write_b32 a38, v252
    v_accvgpr_write_b32 a39, v254
    v_mfma_f32_16x16x32_bf16 v[248:251], v[230:233], a[44:47], v[248:251]
    v_exp_f32 v46, v46
    v_mfma_f32_16x16x32_bf16 v[252:255], v[224:227], a[44:47], 0
    v_exp_f32 v47, v47
    v_mfma_f32_16x16x32_bf16 v[252:255], v[228:231], a[44:47], v[252:255]
    v_cvt_pk_bf16_f32 v56, v40, v41
    v_cvt_pk_bf16_f32 v57, v42, v43
    v_cvt_pk_bf16_f32 v58, v44, v45
    v_cvt_pk_bf16_f32 v59, v46, v47
    v_cvt_pk_bf16_f32 v240, v240, v241
    v_cvt_pk_bf16_f32 v242, v242, v243
    v_mfma_f32_16x16x32_bf16 v[96:99], a[160:163], v[56:59], v[12:15]
    v_cvt_pk_bf16_f32 v244, v244, v245
    v_cvt_pk_bf16_f32 v246, v246, v247
    v_mfma_f32_16x16x32_bf16 v[100:103], a[164:167], v[56:59], v[12:15]
    v_accvgpr_write_b32 a40, v240
    v_accvgpr_write_b32 a41, v242
    v_mfma_f32_16x16x32_bf16 v[104:107], a[168:171], v[56:59], v[12:15]
    v_accvgpr_write_b32 a42, v244
    v_accvgpr_write_b32 a43, v246
    v_mfma_f32_16x16x32_bf16 v[108:111], a[172:175], v[56:59], v[12:15]
    v_cvt_pk_bf16_f32 v248, v248, v249
    v_cvt_pk_bf16_f32 v250, v250, v251
    v_mfma_f32_16x16x32_bf16 v[112:115], a[176:179], v[56:59], v[12:15]
    v_cvt_pk_bf16_f32 v252, v252, v253
    v_cvt_pk_bf16_f32 v254, v254, v255
    v_mfma_f32_16x16x32_bf16 v[116:119], a[180:183], v[56:59], v[12:15]
    v_accvgpr_write_b32 a44, v248
    v_accvgpr_write_b32 a45, v250
    v_mfma_f32_16x16x32_bf16 v[120:123], a[184:187], v[56:59], v[12:15]
    v_accvgpr_write_b32 a46, v252
    v_accvgpr_write_b32 a47, v254
    v_mfma_f32_16x16x32_bf16 v[124:127], a[188:191], v[56:59], v[12:15]
    v_exp_f32 v48, v48
    v_mfma_f32_16x16x32_bf16 a[228:231], a[248:251], v[56:59], 0
    v_exp_f32 v49, v49
    v_mfma_f32_16x16x32_bf16 v[40:43], a[96:99], a[32:35], 0
    v_exp_f32 v50, v50
    v_mfma_f32_16x16x32_bf16 v[40:43], a[100:103], a[36:39], v[40:43]
    v_exp_f32 v51, v51
    v_mfma_f32_16x16x32_bf16 v[40:43], a[104:107], a[40:43], v[40:43]
    v_exp_f32 v52, v52
    v_mfma_f32_16x16x32_bf16 v[40:43], a[108:111], a[44:47], v[40:43]
    v_exp_f32 v53, v53
    v_mfma_f32_16x16x32_bf16 v[44:47], a[112:115], a[32:35], 0
    v_exp_f32 v54, v54
    v_mfma_f32_16x16x32_bf16 v[44:47], a[116:119], a[36:39], v[44:47]
    v_exp_f32 v55, v55
    v_mfma_f32_16x16x32_bf16 v[44:47], a[120:123], a[40:43], v[44:47]
    v_cvt_pk_bf16_f32 v60, v48, v49
    v_cvt_pk_bf16_f32 v61, v50, v51
    v_mfma_f32_16x16x32_bf16 v[44:47], a[124:127], a[44:47], v[44:47]
    s_waitcnt vmcnt(8)
    ds_read_b128 a[48:51], v236 offset:16384
    ds_read_b128 a[52:55], v237 offset:16384
    ds_read_b128 a[56:59], v238 offset:16384
    ds_read_b128 a[60:63], v239 offset:16384
    buffer_load_dwordx4 v3, s[8:11], s21 offen nt lds
    buffer_load_dwordx4 v3, s[8:11], s21 offen offset:2048 nt lds
    s_bitset1_b32 m0, 16
    v_cvt_pk_bf16_f32 v62, v52, v53
    buffer_load_dwordx4 v3, s[12:15], s21 offen nt lds
    buffer_load_dwordx4 v3, s[12:15], s21 offen offset:2048 nt lds
    s_add_u32 s21, s21, 8192
    s_and_b32 s21, s21, 0xffffe000
    s_and_b32 m0, s21, 0xffff
    v_cvt_pk_bf16_f32 v63, v54, v55
    v_max3_f32 v0, v40, v41, v42
    v_max3_f32 v1, v43, v44, v45
    v_mfma_f32_16x16x32_bf16 v[96:99], a[192:195], v[60:63], v[96:99]
    v_max3_f32 v0, v0, v46, v47
    v_max_f32 v0, v0, v1
    v_mfma_f32_16x16x32_bf16 v[100:103], a[196:199], v[60:63], v[100:103]
    v_mov_b32 v1, v0
    v_mfma_f32_16x16x32_bf16 v[104:107], a[200:203], v[60:63], v[104:107]
    s_nop 0
    v_permlane32_swap_b32 v0, v1
    v_mfma_f32_16x16x32_bf16 v[108:111], a[204:207], v[60:63], v[108:111]
    v_max_f32 v0, v0, v1
    v_mov_b32 v1, v0
    v_mfma_f32_16x16x32_bf16 v[112:115], a[208:211], v[60:63], v[112:115]
    s_nop 0
    v_permlane16_swap_b32 v0, v1
    v_mfma_f32_16x16x32_bf16 v[116:119], a[212:215], v[60:63], v[116:119]
    v_max_f32 v0, v0, v1
    v_min_f32 v24, -v0, v24
    v_mfma_f32_16x16x32_bf16 v[120:123], a[216:219], v[60:63], v[120:123]
    v_add_f32 v24, 0xc1300000, v24
    v_mov_b32 v25, v24
    v_mfma_f32_16x16x32_bf16 v[124:127], a[220:223], v[60:63], v[124:127]
    v_mov_b32 v26, v24
    v_mov_b32 v27, v24
    v_mfma_f32_16x16x32_bf16 a[228:231], a[248:251], v[60:63], a[228:231]
    v_add_f32 v40, v40, v24
    v_add_f32 v41, v41, v24
    s_waitcnt lgkmcnt(0)
    v_mfma_f32_16x16x32_bf16 v[240:243], v[226:229], a[48:51], 0
    v_add_f32 v42, v42, v24
    v_add_f32 v43, v43, v24
    v_mfma_f32_16x16x32_bf16 v[240:243], v[230:233], a[48:51], v[240:243]
    v_add_f32 v44, v44, v24
    v_add_f32 v45, v45, v24
    v_mfma_f32_16x16x32_bf16 v[244:247], v[224:227], a[48:51], 0
    v_add_f32 v46, v46, v24
    v_add_f32 v47, v47, v24
    v_mfma_f32_16x16x32_bf16 v[244:247], v[228:231], a[48:51], v[244:247]
    v_exp_f32 v40, v40
    v_mfma_f32_16x16x32_bf16 v[48:51], a[128:131], a[32:35], v[24:27]
    v_cvt_pk_bf16_f32 v240, v240, v241
    v_cvt_pk_bf16_f32 v242, v242, v243
    v_mfma_f32_16x16x32_bf16 v[48:51], a[132:135], a[36:39], v[48:51]
    v_accvgpr_write_b32 a48, v240
    v_accvgpr_write_b32 a49, v242
    v_mfma_f32_16x16x32_bf16 v[48:51], a[136:139], a[40:43], v[48:51]
    v_cvt_pk_bf16_f32 v244, v244, v245
    v_cvt_pk_bf16_f32 v246, v246, v247
    v_mfma_f32_16x16x32_bf16 v[48:51], a[140:143], a[44:47], v[48:51]
    v_accvgpr_write_b32 a50, v244
    v_accvgpr_write_b32 a51, v246
    v_mfma_f32_16x16x32_bf16 v[52:55], a[144:147], a[32:35], v[24:27]
    v_exp_f32 v41, v41
    v_mfma_f32_16x16x32_bf16 v[52:55], a[148:151], a[36:39], v[52:55]
    v_exp_f32 v42, v42
    v_mfma_f32_16x16x32_bf16 v[52:55], a[152:155], a[40:43], v[52:55]
    v_exp_f32 v43, v43
    v_mfma_f32_16x16x32_bf16 v[52:55], a[156:159], a[44:47], v[52:55]
    v_exp_f32 v44, v44
    v_mfma_f32_16x16x32_bf16 v[248:251], v[226:229], a[52:55], 0
    v_exp_f32 v45, v45
    v_mfma_f32_16x16x32_bf16 v[248:251], v[230:233], a[52:55], v[248:251]
    v_exp_f32 v46, v46
    v_mfma_f32_16x16x32_bf16 v[252:255], v[224:227], a[52:55], 0
    v_exp_f32 v47, v47
    v_mfma_f32_16x16x32_bf16 v[252:255], v[228:231], a[52:55], v[252:255]
    v_cvt_pk_bf16_f32 v56, v40, v41
    v_cvt_pk_bf16_f32 v57, v42, v43
    v_mfma_f32_16x16x32_bf16 v[240:243], v[226:229], a[56:59], 0
    v_cvt_pk_bf16_f32 v58, v44, v45
    v_cvt_pk_bf16_f32 v248, v248, v249
    v_mfma_f32_16x16x32_bf16 v[240:243], v[230:233], a[56:59], v[240:243]
    v_cvt_pk_bf16_f32 v250, v250, v251
    v_accvgpr_write_b32 a52, v248
    v_mfma_f32_16x16x32_bf16 v[244:247], v[224:227], a[56:59], 0
    v_accvgpr_write_b32 a53, v250
    v_cvt_pk_bf16_f32 v252, v252, v253
    v_mfma_f32_16x16x32_bf16 v[244:247], v[228:231], a[56:59], v[244:247]
    v_cvt_pk_bf16_f32 v254, v254, v255
    v_accvgpr_write_b32 a54, v252
    v_mfma_f32_16x16x32_bf16 v[248:251], v[226:229], a[60:63], 0
    v_accvgpr_write_b32 a55, v254
    v_cvt_pk_bf16_f32 v59, v46, v47
    v_mfma_f32_16x16x32_bf16 v[248:251], v[230:233], a[60:63], v[248:251]
    v_cvt_pk_bf16_f32 v240, v240, v241
    v_cvt_pk_bf16_f32 v242, v242, v243
    v_mfma_f32_16x16x32_bf16 v[252:255], v[224:227], a[60:63], 0
    v_cvt_pk_bf16_f32 v244, v244, v245
    v_cvt_pk_bf16_f32 v246, v246, v247
    v_mfma_f32_16x16x32_bf16 v[252:255], v[228:231], a[60:63], v[252:255]
    v_accvgpr_write_b32 a56, v240
    v_accvgpr_write_b32 a57, v242
    v_mfma_f32_16x16x32_bf16 v[128:131], a[160:163], v[56:59], v[12:15]
    v_accvgpr_write_b32 a58, v244
    v_accvgpr_write_b32 a59, v246
    v_mfma_f32_16x16x32_bf16 v[132:135], a[164:167], v[56:59], v[12:15]
    v_cvt_pk_bf16_f32 v248, v248, v249
    v_cvt_pk_bf16_f32 v250, v250, v251
    v_mfma_f32_16x16x32_bf16 v[136:139], a[168:171], v[56:59], v[12:15]
    v_cvt_pk_bf16_f32 v252, v252, v253
    v_cvt_pk_bf16_f32 v254, v254, v255
    v_mfma_f32_16x16x32_bf16 v[140:143], a[172:175], v[56:59], v[12:15]
    v_accvgpr_write_b32 a60, v248
    v_accvgpr_write_b32 a61, v250
    v_mfma_f32_16x16x32_bf16 v[144:147], a[176:179], v[56:59], v[12:15]
    v_accvgpr_write_b32 a62, v252
    v_accvgpr_write_b32 a63, v254
    v_mfma_f32_16x16x32_bf16 v[148:151], a[180:183], v[56:59], v[12:15]
    v_exp_f32 v48, v48
    v_mfma_f32_16x16x32_bf16 v[152:155], a[184:187], v[56:59], v[12:15]
    v_exp_f32 v49, v49
    v_mfma_f32_16x16x32_bf16 v[156:159], a[188:191], v[56:59], v[12:15]
    v_exp_f32 v50, v50
    v_mfma_f32_16x16x32_bf16 a[232:235], a[248:251], v[56:59], 0
    v_exp_f32 v51, v51
    v_mfma_f32_16x16x32_bf16 v[40:43], a[96:99], a[48:51], 0
    v_exp_f32 v52, v52
    v_mfma_f32_16x16x32_bf16 v[40:43], a[100:103], a[52:55], v[40:43]
    v_exp_f32 v53, v53
    v_mfma_f32_16x16x32_bf16 v[40:43], a[104:107], a[56:59], v[40:43]
    v_exp_f32 v54, v54
    v_mfma_f32_16x16x32_bf16 v[40:43], a[108:111], a[60:63], v[40:43]
    v_exp_f32 v55, v55
    v_mfma_f32_16x16x32_bf16 v[44:47], a[112:115], a[48:51], 0
    v_cvt_pk_bf16_f32 v60, v48, v49
    v_cvt_pk_bf16_f32 v61, v50, v51
    v_mfma_f32_16x16x32_bf16 v[44:47], a[116:119], a[52:55], v[44:47]
    v_cvt_pk_bf16_f32 v62, v52, v53
    v_cvt_pk_bf16_f32 v63, v54, v55
    v_mfma_f32_16x16x32_bf16 v[44:47], a[120:123], a[56:59], v[44:47]
    v_max3_f32 v0, v40, v41, v42
    v_mfma_f32_16x16x32_bf16 v[44:47], a[124:127], a[60:63], v[44:47]
    s_waitcnt vmcnt(8)
    ds_read_b128 a[64:67], v236 offset:32768
    v_mfma_f32_16x16x32_bf16 v[128:131], a[192:195], v[60:63], v[128:131]
    ds_read_b128 a[68:71], v237 offset:32768
    ds_read_b128 a[72:75], v238 offset:32768
    v_mfma_f32_16x16x32_bf16 v[132:135], a[196:199], v[60:63], v[132:135]
    ds_read_b128 a[76:79], v239 offset:32768
    v_mfma_f32_16x16x32_bf16 v[136:139], a[200:203], v[60:63], v[136:139]
    v_max3_f32 v1, v43, v44, v45
    v_max3_f32 v0, v0, v46, v47
    v_mfma_f32_16x16x32_bf16 v[140:143], a[204:207], v[60:63], v[140:143]
    v_max_f32 v0, v0, v1
    v_mov_b32 v1, v0
    v_mfma_f32_16x16x32_bf16 v[144:147], a[208:211], v[60:63], v[144:147]
    s_nop 0
    v_permlane32_swap_b32 v0, v1
    v_mfma_f32_16x16x32_bf16 v[148:151], a[212:215], v[60:63], v[148:151]
    v_max_f32 v0, v0, v1
    v_mov_b32 v1, v0
    v_mfma_f32_16x16x32_bf16 v[152:155], a[216:219], v[60:63], v[152:155]
    s_nop 0
    v_permlane16_swap_b32 v0, v1
    v_mfma_f32_16x16x32_bf16 v[156:159], a[220:223], v[60:63], v[156:159]
    v_max_f32 v0, v0, v1
    v_min_f32 v28, -v0, v28
    v_mfma_f32_16x16x32_bf16 a[232:235], a[248:251], v[60:63], a[232:235]
    v_add_f32 v28, 0xc1300000, v28
    v_mov_b32 v29, v28
    s_waitcnt lgkmcnt(1)
    v_mfma_f32_16x16x32_bf16 v[240:243], v[226:229], a[64:67], 0
    v_mov_b32 v30, v28
    v_mov_b32 v31, v28
    v_mfma_f32_16x16x32_bf16 v[240:243], v[230:233], a[64:67], v[240:243]
    v_add_f32 v40, v40, v28
    v_add_f32 v41, v41, v28
    v_mfma_f32_16x16x32_bf16 v[244:247], v[224:227], a[64:67], 0
    v_add_f32 v42, v42, v28
    v_add_f32 v43, v43, v28
    v_mfma_f32_16x16x32_bf16 v[244:247], v[228:231], a[64:67], v[244:247]
    v_add_f32 v44, v44, v28
    v_add_f32 v45, v45, v28
    v_mfma_f32_16x16x32_bf16 v[48:51], a[128:131], a[48:51], v[28:31]
    v_cvt_pk_bf16_f32 v240, v240, v241
    v_cvt_pk_bf16_f32 v242, v242, v243
    v_mfma_f32_16x16x32_bf16 v[48:51], a[132:135], a[52:55], v[48:51]
    v_accvgpr_write_b32 a64, v240
    v_accvgpr_write_b32 a65, v242
    v_mfma_f32_16x16x32_bf16 v[48:51], a[136:139], a[56:59], v[48:51]
    v_cvt_pk_bf16_f32 v244, v244, v245
    v_cvt_pk_bf16_f32 v246, v246, v247
    v_mfma_f32_16x16x32_bf16 v[48:51], a[140:143], a[60:63], v[48:51]
    v_accvgpr_write_b32 a66, v244
    v_accvgpr_write_b32 a67, v246
    v_mfma_f32_16x16x32_bf16 v[52:55], a[144:147], a[48:51], v[28:31]
    v_add_f32 v46, v46, v28
    v_add_f32 v47, v47, v28
    v_mfma_f32_16x16x32_bf16 v[52:55], a[148:151], a[52:55], v[52:55]
    v_exp_f32 v40, v40
    v_mfma_f32_16x16x32_bf16 v[52:55], a[152:155], a[56:59], v[52:55]
    v_exp_f32 v41, v41
    v_mfma_f32_16x16x32_bf16 v[52:55], a[156:159], a[60:63], v[52:55]
    v_exp_f32 v42, v42
    v_mfma_f32_16x16x32_bf16 v[248:251], v[226:229], a[68:71], 0
    v_exp_f32 v43, v43
    v_mfma_f32_16x16x32_bf16 v[248:251], v[230:233], a[68:71], v[248:251]
    v_exp_f32 v44, v44
    v_mfma_f32_16x16x32_bf16 v[252:255], v[224:227], a[68:71], 0
    v_exp_f32 v45, v45
    v_mfma_f32_16x16x32_bf16 v[252:255], v[228:231], a[68:71], v[252:255]
    v_exp_f32 v46, v46
    v_mfma_f32_16x16x32_bf16 v[240:243], v[226:229], a[72:75], 0
    v_exp_f32 v47, v47
    v_mfma_f32_16x16x32_bf16 v[240:243], v[230:233], a[72:75], v[240:243]
    v_cvt_pk_bf16_f32 v248, v248, v249
    v_cvt_pk_bf16_f32 v250, v250, v251
    v_mfma_f32_16x16x32_bf16 v[244:247], v[224:227], a[72:75], 0
    v_accvgpr_write_b32 a68, v248
    v_accvgpr_write_b32 a69, v250
    v_mfma_f32_16x16x32_bf16 v[244:247], v[228:231], a[72:75], v[244:247]
    v_cvt_pk_bf16_f32 v252, v252, v253
    v_cvt_pk_bf16_f32 v254, v254, v255
    s_waitcnt lgkmcnt(0)
    v_mfma_f32_16x16x32_bf16 v[248:251], v[226:229], a[76:79], 0
    v_accvgpr_write_b32 a70, v252
    v_accvgpr_write_b32 a71, v254
    v_mfma_f32_16x16x32_bf16 v[248:251], v[230:233], a[76:79], v[248:251]
    v_cvt_pk_bf16_f32 v56, v40, v41
    v_cvt_pk_bf16_f32 v57, v42, v43
    v_mfma_f32_16x16x32_bf16 v[252:255], v[224:227], a[76:79], 0
    v_cvt_pk_bf16_f32 v58, v44, v45
    v_cvt_pk_bf16_f32 v59, v46, v47
    v_mfma_f32_16x16x32_bf16 v[252:255], v[228:231], a[76:79], v[252:255]
    v_cvt_pk_bf16_f32 v240, v240, v241
    v_cvt_pk_bf16_f32 v242, v242, v243
    v_mfma_f32_16x16x32_bf16 v[160:163], a[160:163], v[56:59], v[12:15]
    v_cvt_pk_bf16_f32 v244, v244, v245
    v_cvt_pk_bf16_f32 v246, v246, v247
    v_mfma_f32_16x16x32_bf16 v[164:167], a[164:167], v[56:59], v[12:15]
    v_accvgpr_write_b32 a72, v240
    v_accvgpr_write_b32 a73, v242
    v_mfma_f32_16x16x32_bf16 v[168:171], a[168:171], v[56:59], v[12:15]
    v_accvgpr_write_b32 a74, v244
    v_accvgpr_write_b32 a75, v246
    v_mfma_f32_16x16x32_bf16 v[172:175], a[172:175], v[56:59], v[12:15]
    v_cvt_pk_bf16_f32 v248, v248, v249
    v_cvt_pk_bf16_f32 v250, v250, v251
    v_mfma_f32_16x16x32_bf16 v[176:179], a[176:179], v[56:59], v[12:15]
    v_cvt_pk_bf16_f32 v252, v252, v253
    v_cvt_pk_bf16_f32 v254, v254, v255
    v_mfma_f32_16x16x32_bf16 v[180:183], a[180:183], v[56:59], v[12:15]
    v_accvgpr_write_b32 a76, v248
    v_accvgpr_write_b32 a77, v250
    v_mfma_f32_16x16x32_bf16 v[184:187], a[184:187], v[56:59], v[12:15]
    v_accvgpr_write_b32 a78, v252
    v_accvgpr_write_b32 a79, v254
    v_mfma_f32_16x16x32_bf16 v[188:191], a[188:191], v[56:59], v[12:15]
    v_exp_f32 v48, v48
    v_mfma_f32_16x16x32_bf16 a[236:239], a[248:251], v[56:59], 0
    v_exp_f32 v49, v49
    v_mfma_f32_16x16x32_bf16 v[40:43], a[96:99], a[64:67], 0
    v_exp_f32 v50, v50
    v_mfma_f32_16x16x32_bf16 v[40:43], a[100:103], a[68:71], v[40:43]
    v_exp_f32 v51, v51
    v_mfma_f32_16x16x32_bf16 v[40:43], a[104:107], a[72:75], v[40:43]
    v_exp_f32 v52, v52
    v_mfma_f32_16x16x32_bf16 v[40:43], a[108:111], a[76:79], v[40:43]
    v_exp_f32 v53, v53
    v_mfma_f32_16x16x32_bf16 v[44:47], a[112:115], a[64:67], 0
    v_exp_f32 v54, v54
    v_mfma_f32_16x16x32_bf16 v[44:47], a[116:119], a[68:71], v[44:47]
    v_exp_f32 v55, v55
    v_mfma_f32_16x16x32_bf16 v[44:47], a[120:123], a[72:75], v[44:47]
    v_cvt_pk_bf16_f32 v60, v48, v49
    v_cvt_pk_bf16_f32 v61, v50, v51
    v_mfma_f32_16x16x32_bf16 v[44:47], a[124:127], a[76:79], v[44:47]
    v_cvt_pk_bf16_f32 v62, v52, v53
    v_cvt_pk_bf16_f32 v63, v54, v55
    v_max3_f32 v0, v40, v41, v42
    s_nop 0
    v_mfma_f32_16x16x32_bf16 v[160:163], a[192:195], v[60:63], v[160:163]
    v_mfma_f32_16x16x32_bf16 v[164:167], a[196:199], v[60:63], v[164:167]
    s_waitcnt vmcnt(6)
    s_barrier
    v_mfma_f32_16x16x32_bf16 v[168:171], a[200:203], v[60:63], v[168:171]
    ds_read_b128 a[96:99], v4 offset:16384
    v_max3_f32 v1, v43, v44, v45
    v_mfma_f32_16x16x32_bf16 v[172:175], a[204:207], v[60:63], v[172:175]
    ds_read_b128 a[100:103], v5 offset:16384
    v_max3_f32 v0, v0, v46, v47
    v_mfma_f32_16x16x32_bf16 v[176:179], a[208:211], v[60:63], v[176:179]
    ds_read_b128 a[104:107], v6 offset:16384
    v_max_f32 v0, v0, v1
    v_mfma_f32_16x16x32_bf16 v[180:183], a[212:215], v[60:63], v[180:183]
    ds_read_b128 a[108:111], v7 offset:16384
    v_mov_b32 v1, v0
    v_mfma_f32_16x16x32_bf16 v[184:187], a[216:219], v[60:63], v[184:187]
    ds_read_b128 a[112:115], v4 offset:20480
    v_xor_b32 v4, s23, v4
    v_mfma_f32_16x16x32_bf16 v[188:191], a[220:223], v[60:63], v[188:191]
    ds_read_b128 a[116:119], v5 offset:20480
    v_xor_b32 v5, s23, v5
    v_mfma_f32_16x16x32_bf16 a[236:239], a[248:251], v[60:63], a[236:239]
    ds_read_b128 a[120:123], v6 offset:20480
    ds_read_b128 a[124:127], v7 offset:20480
    buffer_load_dwordx4 v234, s[8:11], s21 offen offset:0 nt lds
    buffer_load_dwordx4 v3, s[8:11], s21 offen offset:1024 nt lds
    buffer_load_dwordx4 v234, s[8:11], s21 offen offset:2048 nt lds
    buffer_load_dwordx4 v3, s[8:11], s21 offen offset:3072 nt lds
    s_bitset1_b32 m0, 16
    v_permlane32_swap_b32 v0, v1
    buffer_load_dwordx4 v234, s[12:15], s21 offen offset:0 nt lds
    buffer_load_dwordx4 v3, s[12:15], s21 offen offset:1024 nt lds
    buffer_load_dwordx4 v234, s[12:15], s21 offen offset:2048 nt lds
    buffer_load_dwordx4 v3, s[12:15], s21 offen offset:3072 nt lds
    s_add_u32 s21, s21, 4096
    s_and_b32 m0, s21, 0xffff
    v_max_f32 v0, v0, v1
    buffer_load_dwordx4 v234, s[8:11], s21 offen offset:0 nt lds
    buffer_load_dwordx4 v3, s[8:11], s21 offen offset:1024 nt lds
    buffer_load_dwordx4 v234, s[8:11], s21 offen offset:2048 nt lds
    buffer_load_dwordx4 v3, s[8:11], s21 offen offset:3072 nt lds
    s_bitset1_b32 m0, 16
    v_mov_b32 v1, v0
    buffer_load_dwordx4 v234, s[12:15], s21 offen offset:0 nt lds
    buffer_load_dwordx4 v3, s[12:15], s21 offen offset:1024 nt lds
    buffer_load_dwordx4 v234, s[12:15], s21 offen offset:2048 nt lds
    buffer_load_dwordx4 v3, s[12:15], s21 offen offset:3072 nt lds
    s_add_u32 s21, s21, 4096
    s_and_b32 m0, s21, 0xffff
    v_permlane16_swap_b32 v0, v1
    v_max_f32 v0, v0, v1
    v_min_f32 v32, -v0, v32
    v_add_f32 v32, 0xc1300000, v32
    v_mov_b32 v33, v32
    v_mov_b32 v34, v32
    v_mov_b32 v35, v32
    v_add_f32 v40, v40, v32
    v_add_f32 v41, v41, v32
    v_mfma_f32_16x16x32_bf16 v[48:51], a[128:131], a[64:67], v[32:35]
    v_add_f32 v42, v42, v32
    v_add_f32 v43, v43, v32
    v_mfma_f32_16x16x32_bf16 v[48:51], a[132:135], a[68:71], v[48:51]
    v_add_f32 v44, v44, v32
    v_add_f32 v45, v45, v32
    v_mfma_f32_16x16x32_bf16 v[48:51], a[136:139], a[72:75], v[48:51]
    v_add_f32 v46, v46, v32
    v_add_f32 v47, v47, v32
    v_mfma_f32_16x16x32_bf16 v[48:51], a[140:143], a[76:79], v[48:51]
    v_exp_f32 v40, v40
    v_mfma_f32_16x16x32_bf16 v[52:55], a[144:147], a[64:67], v[32:35]
    v_exp_f32 v41, v41
    v_mfma_f32_16x16x32_bf16 v[52:55], a[148:151], a[68:71], v[52:55]
    v_exp_f32 v42, v42
    v_mfma_f32_16x16x32_bf16 v[52:55], a[152:155], a[72:75], v[52:55]
    v_exp_f32 v43, v43
    v_mfma_f32_16x16x32_bf16 v[52:55], a[156:159], a[76:79], v[52:55]
    v_exp_f32 v44, v44
    v_exp_f32 v45, v45
    v_exp_f32 v46, v46
    v_exp_f32 v47, v47
    v_cvt_pk_bf16_f32 v56, v40, v41
    v_cvt_pk_bf16_f32 v57, v42, v43
    v_cvt_pk_bf16_f32 v58, v44, v45
    v_cvt_pk_bf16_f32 v59, v46, v47
    v_exp_f32 v48, v48
    v_xor_b32 v6, s23, v6
    v_mfma_f32_16x16x32_bf16 v[192:195], a[160:163], v[56:59], v[12:15]
    v_exp_f32 v49, v49
    v_mfma_f32_16x16x32_bf16 v[196:199], a[164:167], v[56:59], v[12:15]
    s_waitcnt vmcnt(20)
    s_barrier
    v_mfma_f32_16x16x32_bf16 v[200:203], a[168:171], v[56:59], v[12:15]
    s_waitcnt lgkmcnt(0)
    ds_read_b64_tr_b16 a[160:161], v8 offset:16384
    v_mfma_f32_16x16x32_bf16 v[204:207], a[172:175], v[56:59], v[12:15]
    ds_read_b64_tr_b16 a[162:163], v8 offset:20480
    ds_read_b64_tr_b16 a[164:165], v8 offset:16392
    v_mfma_f32_16x16x32_bf16 v[208:211], a[176:179], v[56:59], v[12:15]
    ds_read_b64_tr_b16 a[166:167], v8 offset:20488
    ds_read_b64_tr_b16 a[168:169], v9 offset:16384
    v_mfma_f32_16x16x32_bf16 v[212:215], a[180:183], v[56:59], v[12:15]
    ds_read_b64_tr_b16 a[170:171], v9 offset:20480
    ds_read_b64_tr_b16 a[172:173], v9 offset:16392
    v_mfma_f32_16x16x32_bf16 v[216:219], a[184:187], v[56:59], v[12:15]
    ds_read_b64_tr_b16 a[174:175], v9 offset:20488
    ds_read_b64_tr_b16 a[176:177], v10 offset:16384
    v_mfma_f32_16x16x32_bf16 v[220:223], a[188:191], v[56:59], v[12:15]
    ds_read_b64_tr_b16 a[178:179], v10 offset:20480
    ds_read_b64_tr_b16 a[180:181], v10 offset:16392
    v_mfma_f32_16x16x32_bf16 a[240:243], a[248:251], v[56:59], 0
    ds_read_b64_tr_b16 a[182:183], v10 offset:20488
    ds_read_b64_tr_b16 a[184:185], v11 offset:16384
    v_mfma_f32_16x16x32_bf16 v[40:43], a[96:99], a[0:3], v[16:19]
    ds_read_b64_tr_b16 a[186:187], v11 offset:20480
    ds_read_b64_tr_b16 a[188:189], v11 offset:16392
    v_mfma_f32_16x16x32_bf16 v[40:43], a[100:103], a[4:7], v[40:43]
    ds_read_b64_tr_b16 a[190:191], v11 offset:20488
    buffer_load_dwordx4 v234, s[8:11], s21 offen offset:0 nt lds
    v_mfma_f32_16x16x32_bf16 v[40:43], a[104:107], a[8:11], v[40:43]
    buffer_load_dwordx4 v3, s[8:11], s21 offen offset:1024 nt lds
    v_mfma_f32_16x16x32_bf16 v[40:43], a[108:111], a[12:15], v[40:43]
    buffer_load_dwordx4 v234, s[8:11], s21 offen offset:2048 nt lds
    v_mfma_f32_16x16x32_bf16 v[44:47], a[112:115], a[0:3], v[16:19]
    buffer_load_dwordx4 v3, s[8:11], s21 offen offset:3072 nt lds
    v_mfma_f32_16x16x32_bf16 v[44:47], a[116:119], a[4:7], v[44:47]
    s_bitset1_b32 m0, 16
    v_exp_f32 v50, v50
    v_mfma_f32_16x16x32_bf16 v[44:47], a[120:123], a[8:11], v[44:47]
    buffer_load_dwordx4 v234, s[12:15], s21 offen offset:0 nt lds
    v_mfma_f32_16x16x32_bf16 v[44:47], a[124:127], a[12:15], v[44:47]
    buffer_load_dwordx4 v3, s[12:15], s21 offen offset:1024 nt lds
    buffer_load_dwordx4 v234, s[12:15], s21 offen offset:2048 nt lds
    buffer_load_dwordx4 v3, s[12:15], s21 offen offset:3072 nt lds
    s_add_u32 s21, s21, 4096
    s_and_b32 m0, s21, 0xffff
    v_exp_f32 v51, v51
    buffer_load_dwordx4 v234, s[8:11], s21 offen offset:0 nt lds
    buffer_load_dwordx4 v3, s[8:11], s21 offen offset:1024 nt lds
    buffer_load_dwordx4 v234, s[8:11], s21 offen offset:2048 nt lds
    buffer_load_dwordx4 v3, s[8:11], s21 offen offset:3072 nt lds
    s_bitset1_b32 m0, 16
    v_exp_f32 v52, v52
    buffer_load_dwordx4 v234, s[12:15], s21 offen offset:0 nt lds
    buffer_load_dwordx4 v3, s[12:15], s21 offen offset:1024 nt lds
    buffer_load_dwordx4 v234, s[12:15], s21 offen offset:2048 nt lds
    buffer_load_dwordx4 v3, s[12:15], s21 offen offset:3072 nt lds
    v_exp_f32 v53, v53
    v_exp_f32 v54, v54
    v_exp_f32 v55, v55
    v_xor_b32 v7, s23, v7
    v_xor_b32 v8, s23, v8
    v_xor_b32 v9, s23, v9
    v_xor_b32 v10, s23, v10
    v_xor_b32 v11, s23, v11
    s_add_u32 s21, s21, 4096
    s_mov_b32 s23, 0xc000
    v_mov_b32 v0, 0
    v_mov_b32 v1, 0
    v_mov_b32 v12, 0
    v_mov_b32 v13, 0
    v_cvt_pk_bf16_f32 v60, v48, v49
    v_cvt_pk_bf16_f32 v61, v50, v51
    v_cvt_pk_bf16_f32 v62, v52, v53
    v_cvt_pk_bf16_f32 v63, v54, v55
    s_nop 1
.p2align 6
L_loop5:
    v_mfma_f32_16x16x32_bf16 v[192:195], a[192:195], v[60:63], v[192:195]
    s_waitcnt lgkmcnt(0)
    s_and_b32 m0, s21, 0xffff
    v_mfma_f32_16x16x32_bf16 v[196:199], a[196:199], v[60:63], v[196:199]
    v_exp_f32 v40, v40
    v_mfma_f32_16x16x32_bf16 v[200:203], a[200:203], v[60:63], v[200:203]
    v_exp_f32 v41, v41
    v_mfma_f32_16x16x32_bf16 v[204:207], a[204:207], v[60:63], v[204:207]
    v_exp_f32 v42, v42
    v_mfma_f32_16x16x32_bf16 v[208:211], a[208:211], v[60:63], v[208:211]
    v_exp_f32 v43, v43
    v_mfma_f32_16x16x32_bf16 v[212:215], a[212:215], v[60:63], v[212:215]
    v_exp_f32 v44, v44
    v_mfma_f32_16x16x32_bf16 v[216:219], a[216:219], v[60:63], v[216:219]
    v_exp_f32 v45, v45
    v_mfma_f32_16x16x32_bf16 v[220:223], a[220:223], v[60:63], v[220:223]
    v_exp_f32 v46, v46
    v_mfma_f32_16x16x32_bf16 a[240:243], a[248:251], v[60:63], a[240:243]
    v_exp_f32 v47, v47
    v_mfma_f32_16x16x32_bf16 v[48:51], a[96:99], a[16:19], v[20:23]
    v_cvt_pk_bf16_f32 v56, v40, v41
    v_cvt_pk_bf16_f32 v57, v42, v43
    v_mfma_f32_16x16x32_bf16 v[48:51], a[100:103], a[20:23], v[48:51]
    s_waitcnt vmcnt(32)
    s_barrier
    v_mfma_f32_16x16x32_bf16 v[48:51], a[104:107], a[24:27], v[48:51]
    ds_read_b128 a[128:131], v4 offset:8192
    v_cvt_pk_bf16_f32 v58, v44, v45
    v_mfma_f32_16x16x32_bf16 v[48:51], a[108:111], a[28:31], v[48:51]
    buffer_load_dwordx4 v234, s[8:11], s21 offen offset:0 nt lds
    v_mfma_f32_16x16x32_bf16 v[52:55], a[112:115], a[16:19], v[20:23]
    ds_read_b128 a[132:135], v5 offset:8192
    v_cvt_pk_bf16_f32 v59, v46, v47
    v_mfma_f32_16x16x32_bf16 v[52:55], a[116:119], a[20:23], v[52:55]
    buffer_load_dwordx4 v3, s[8:11], s21 offen offset:1024 nt lds
    v_mfma_f32_16x16x32_bf16 v[52:55], a[120:123], a[24:27], v[52:55]
    ds_read_b128 a[136:139], v6 offset:8192
    v_mfma_f32_16x16x32_bf16 v[52:55], a[124:127], a[28:31], v[52:55]
    v_exp_f32 v48, v48
    v_mfma_f32_16x16x32_bf16 v[64:67], a[160:163], v[56:59], v[64:67]
    v_exp_f32 v49, v49
    v_mfma_f32_16x16x32_bf16 v[68:71], a[164:167], v[56:59], v[68:71]
    ds_read_b128 a[140:143], v7 offset:8192
    v_cvt_pk_bf16_f32 v60, v48, v49
    v_mfma_f32_16x16x32_bf16 v[72:75], a[168:171], v[56:59], v[72:75]
    v_exp_f32 v50, v50
    v_mfma_f32_16x16x32_bf16 v[76:79], a[172:175], v[56:59], v[76:79]
    v_exp_f32 v51, v51
    v_mfma_f32_16x16x32_bf16 v[80:83], a[176:179], v[56:59], v[80:83]
    v_exp_f32 v52, v52
    v_mfma_f32_16x16x32_bf16 v[84:87], a[180:183], v[56:59], v[84:87]
    v_exp_f32 v53, v53
    v_mfma_f32_16x16x32_bf16 v[88:91], a[184:187], v[56:59], v[88:91]
    v_exp_f32 v54, v54
    v_mfma_f32_16x16x32_bf16 v[92:95], a[188:191], v[56:59], v[92:95]
    v_exp_f32 v55, v55
    v_mfma_f32_16x16x32_bf16 a[224:227], a[248:251], v[56:59], a[224:227]
    v_cvt_pk_bf16_f32 v61, v50, v51
    v_cvt_pk_bf16_f32 v62, v52, v53
    v_mfma_f32_16x16x32_bf16 v[40:43], a[96:99], a[32:35], v[24:27]
    buffer_load_dwordx4 v234, s[8:11], s21 offen offset:2048 nt lds
    v_mfma_f32_16x16x32_bf16 v[40:43], a[100:103], a[36:39], v[40:43]
    ds_read_b128 a[144:147], v4 offset:12288
    v_cvt_pk_bf16_f32 v63, v54, v55
    v_mfma_f32_16x16x32_bf16 v[40:43], a[104:107], a[40:43], v[40:43]
    buffer_load_dwordx4 v3, s[8:11], s21 offen offset:3072 nt lds
    v_mfma_f32_16x16x32_bf16 v[40:43], a[108:111], a[44:47], v[40:43]
    s_bitset1_b32 m0, 16
    v_mfma_f32_16x16x32_bf16 v[44:47], a[112:115], a[32:35], v[24:27]
    ds_read_b128 a[148:151], v5 offset:12288
    v_mfma_f32_16x16x32_bf16 v[44:47], a[116:119], a[36:39], v[44:47]
    ds_read_b128 a[152:155], v6 offset:12288
    v_mfma_f32_16x16x32_bf16 v[44:47], a[120:123], a[40:43], v[44:47]
    buffer_load_dwordx4 v234, s[12:15], s21 offen offset:0 nt lds
    v_mfma_f32_16x16x32_bf16 v[44:47], a[124:127], a[44:47], v[44:47]
    v_exp_f32 v40, v40
    v_mfma_f32_16x16x32_bf16 v[96:99], a[160:163], v[60:63], v[96:99]
    v_exp_f32 v41, v41
    v_mfma_f32_16x16x32_bf16 v[100:103], a[164:167], v[60:63], v[100:103]
    ds_read_b128 a[156:159], v7 offset:12288
    v_cvt_pk_bf16_f32 v56, v40, v41
    v_mfma_f32_16x16x32_bf16 v[104:107], a[168:171], v[60:63], v[104:107]
    v_exp_f32 v42, v42
    v_mfma_f32_16x16x32_bf16 v[108:111], a[172:175], v[60:63], v[108:111]
    v_exp_f32 v43, v43
    v_mfma_f32_16x16x32_bf16 v[112:115], a[176:179], v[60:63], v[112:115]
    v_exp_f32 v44, v44
    v_mfma_f32_16x16x32_bf16 v[116:119], a[180:183], v[60:63], v[116:119]
    v_exp_f32 v45, v45
    v_mfma_f32_16x16x32_bf16 v[120:123], a[184:187], v[60:63], v[120:123]
    v_exp_f32 v46, v46
    v_mfma_f32_16x16x32_bf16 v[124:127], a[188:191], v[60:63], v[124:127]
    v_exp_f32 v47, v47
    v_mfma_f32_16x16x32_bf16 a[228:231], a[248:251], v[60:63], a[228:231]
    v_cvt_pk_bf16_f32 v57, v42, v43
    v_cvt_pk_bf16_f32 v58, v44, v45
    v_mfma_f32_16x16x32_bf16 v[48:51], a[96:99], a[48:51], v[28:31]
    buffer_load_dwordx4 v3, s[12:15], s21 offen offset:1024 nt lds
    v_mfma_f32_16x16x32_bf16 v[48:51], a[100:103], a[52:55], v[48:51]
    ds_read_b64_tr_b16 a[192:193], v8 offset:8192
    v_cvt_pk_bf16_f32 v59, v46, v47
    v_mfma_f32_16x16x32_bf16 v[48:51], a[104:107], a[56:59], v[48:51]
    s_waitcnt lgkmcnt(1)
    v_mfma_f32_16x16x32_bf16 v[48:51], a[108:111], a[60:63], v[48:51]
    buffer_load_dwordx4 v234, s[12:15], s21 offen offset:2048 nt lds
    v_mfma_f32_16x16x32_bf16 v[52:55], a[112:115], a[48:51], v[28:31]
    ds_read_b64_tr_b16 a[194:195], v8 offset:12288
    v_mfma_f32_16x16x32_bf16 v[52:55], a[116:119], a[52:55], v[52:55]
    ds_read_b64_tr_b16 a[196:197], v8 offset:8200
    v_mfma_f32_16x16x32_bf16 v[52:55], a[120:123], a[56:59], v[52:55]
    buffer_load_dwordx4 v3, s[12:15], s21 offen offset:3072 nt lds
    v_mfma_f32_16x16x32_bf16 v[52:55], a[124:127], a[60:63], v[52:55]
    s_add_u32 s21, s21, 4096
    v_exp_f32 v48, v48
    v_mfma_f32_16x16x32_bf16 v[128:131], a[160:163], v[56:59], v[128:131]
    s_and_b32 m0, s21, 0xffff
    v_exp_f32 v49, v49
    v_mfma_f32_16x16x32_bf16 v[132:135], a[164:167], v[56:59], v[132:135]
    ds_read_b64_tr_b16 a[198:199], v8 offset:12296
    v_cvt_pk_bf16_f32 v60, v48, v49
    v_mfma_f32_16x16x32_bf16 v[136:139], a[168:171], v[56:59], v[136:139]
    v_exp_f32 v50, v50
    v_mfma_f32_16x16x32_bf16 v[140:143], a[172:175], v[56:59], v[140:143]
    v_exp_f32 v51, v51
    v_mfma_f32_16x16x32_bf16 v[144:147], a[176:179], v[56:59], v[144:147]
    ds_read_b64_tr_b16 a[200:201], v9 offset:8192
    v_cvt_pk_bf16_f32 v61, v50, v51
    v_mfma_f32_16x16x32_bf16 v[148:151], a[180:183], v[56:59], v[148:151]
    v_exp_f32 v52, v52
    v_mfma_f32_16x16x32_bf16 v[152:155], a[184:187], v[56:59], v[152:155]
    v_exp_f32 v53, v53
    v_mfma_f32_16x16x32_bf16 v[156:159], a[188:191], v[56:59], v[156:159]
    v_exp_f32 v54, v54
    v_mfma_f32_16x16x32_bf16 a[232:235], a[248:251], v[56:59], a[232:235]
    v_exp_f32 v55, v55
    v_mfma_f32_16x16x32_bf16 v[40:43], a[96:99], a[64:67], v[32:35]
    v_cvt_pk_bf16_f32 v62, v52, v53
    v_cvt_pk_bf16_f32 v63, v54, v55
    v_mfma_f32_16x16x32_bf16 v[40:43], a[100:103], a[68:71], v[40:43]
    buffer_load_dwordx4 v234, s[8:11], s21 offen offset:0 nt lds
    v_mfma_f32_16x16x32_bf16 v[40:43], a[104:107], a[72:75], v[40:43]
    ds_read_b64_tr_b16 a[202:203], v9 offset:12288
    v_mfma_f32_16x16x32_bf16 v[40:43], a[108:111], a[76:79], v[40:43]
    buffer_load_dwordx4 v3, s[8:11], s21 offen offset:1024 nt lds
    v_mfma_f32_16x16x32_bf16 v[44:47], a[112:115], a[64:67], v[32:35]
    ds_read_b64_tr_b16 a[204:205], v9 offset:8200
    v_mfma_f32_16x16x32_bf16 v[44:47], a[116:119], a[68:71], v[44:47]
    ds_read_b64_tr_b16 a[206:207], v9 offset:12296
    v_mfma_f32_16x16x32_bf16 v[44:47], a[120:123], a[72:75], v[44:47]
    buffer_load_dwordx4 v234, s[8:11], s21 offen offset:2048 nt lds
    v_mfma_f32_16x16x32_bf16 v[44:47], a[124:127], a[76:79], v[44:47]
    v_exp_f32 v40, v40
    v_mfma_f32_16x16x32_bf16 v[160:163], a[160:163], v[60:63], v[160:163]
    v_exp_f32 v41, v41
    v_mfma_f32_16x16x32_bf16 v[164:167], a[164:167], v[60:63], v[164:167]
    ds_read_b64_tr_b16 a[208:209], v10 offset:8192
    v_cvt_pk_bf16_f32 v56, v40, v41
    v_mfma_f32_16x16x32_bf16 v[168:171], a[168:171], v[60:63], v[168:171]
    buffer_load_dwordx4 v3, s[8:11], s21 offen offset:3072 nt lds
    v_mfma_f32_16x16x32_bf16 v[172:175], a[172:175], v[60:63], v[172:175]
    s_bitset1_b32 m0, 16
    v_exp_f32 v42, v42
    v_mfma_f32_16x16x32_bf16 v[176:179], a[176:179], v[60:63], v[176:179]
    v_exp_f32 v43, v43
    v_mfma_f32_16x16x32_bf16 v[180:183], a[180:183], v[60:63], v[180:183]
    ds_read_b64_tr_b16 a[210:211], v10 offset:12288
    v_cvt_pk_bf16_f32 v57, v42, v43
    v_mfma_f32_16x16x32_bf16 v[184:187], a[184:187], v[60:63], v[184:187]
    v_exp_f32 v44, v44
    v_mfma_f32_16x16x32_bf16 v[188:191], a[188:191], v[60:63], v[188:191]
    v_exp_f32 v45, v45
    v_mfma_f32_16x16x32_bf16 a[236:239], a[248:251], v[60:63], a[236:239]
    ds_read_b64_tr_b16 a[212:213], v10 offset:8200
    v_cvt_pk_bf16_f32 v58, v44, v45
    v_mfma_f32_16x16x32_bf16 v[48:51], a[128:131], a[0:3], v[16:19]
    buffer_load_dwordx4 v234, s[12:15], s21 offen offset:0 nt lds
    v_mfma_f32_16x16x32_bf16 v[48:51], a[132:135], a[4:7], v[48:51]
    v_exp_f32 v46, v46
    v_mfma_f32_16x16x32_bf16 v[48:51], a[136:139], a[8:11], v[48:51]
    v_exp_f32 v47, v47
    v_mfma_f32_16x16x32_bf16 v[48:51], a[140:143], a[12:15], v[48:51]
    ds_read_b64_tr_b16 a[214:215], v10 offset:12296
    v_cvt_pk_bf16_f32 v59, v46, v47
    v_mfma_f32_16x16x32_bf16 v[52:55], a[144:147], a[0:3], v[16:19]
    buffer_load_dwordx4 v3, s[12:15], s21 offen offset:1024 nt lds
    v_mfma_f32_16x16x32_bf16 v[52:55], a[148:151], a[4:7], v[52:55]
    ds_read_b64_tr_b16 a[216:217], v11 offset:8192
    v_mfma_f32_16x16x32_bf16 v[52:55], a[152:155], a[8:11], v[52:55]
    buffer_load_dwordx4 v234, s[12:15], s21 offen offset:2048 nt lds
    v_mfma_f32_16x16x32_bf16 v[52:55], a[156:159], a[12:15], v[52:55]
    ds_read_b64_tr_b16 a[218:219], v11 offset:12288
    ds_read_b64_tr_b16 a[220:221], v11 offset:8200
    buffer_load_dwordx4 v3, s[12:15], s21 offen offset:3072 nt lds
    ds_read_b64_tr_b16 a[222:223], v11 offset:12296
    s_add_u32 s21, s21, 4096
L_odd5:
    v_mfma_f32_16x16x32_bf16 v[192:195], a[160:163], v[56:59], v[192:195]
    s_waitcnt lgkmcnt(0)
    v_xor_b32 v11, s23, v11
    v_xor_b32 v7, s23, v7
    v_mfma_f32_16x16x32_bf16 v[196:199], a[164:167], v[56:59], v[196:199]
    v_exp_f32 v48, v48
    v_mfma_f32_16x16x32_bf16 v[200:203], a[168:171], v[56:59], v[200:203]
    v_exp_f32 v50, v50
    v_mfma_f32_16x16x32_bf16 v[204:207], a[172:175], v[56:59], v[204:207]
    v_exp_f32 v54, v54
    v_mfma_f32_16x16x32_bf16 v[208:211], a[176:179], v[56:59], v[208:211]
    v_exp_f32 v55, v55
    v_mfma_f32_16x16x32_bf16 v[212:215], a[180:183], v[56:59], v[212:215]
    v_exp_f32 v51, v51
    v_mfma_f32_16x16x32_bf16 v[216:219], a[184:187], v[56:59], v[216:219]
    v_cvt_pk_bf16_f32 v61, v50, v51
    v_cvt_pk_bf16_f32 v63, v54, v55
    v_mfma_f32_16x16x32_bf16 v[220:223], a[188:191], v[56:59], v[220:223]
    v_exp_f32 v52, v52
    v_mfma_f32_16x16x32_bf16 a[240:243], a[248:251], v[56:59], a[240:243]
    v_exp_f32 v53, v53
    v_mfma_f32_16x16x32_bf16 v[40:43], a[128:131], a[16:19], v[20:23]
    v_cvt_pk_bf16_f32 v62, v52, v53
    v_xor_b32 v9, s23, v9
    v_mfma_f32_16x16x32_bf16 v[40:43], a[132:135], a[20:23], v[40:43]
    s_waitcnt vmcnt(32)
    s_barrier
    v_mfma_f32_16x16x32_bf16 v[40:43], a[136:139], a[24:27], v[40:43]
    v_exp_f32 v49, v49
    v_mfma_f32_16x16x32_bf16 v[40:43], a[140:143], a[28:31], v[40:43]
    v_cvt_pk_bf16_f32 v60, v48, v49
    v_xor_b32 v10, s23, v10
    v_mfma_f32_16x16x32_bf16 v[44:47], a[144:147], a[16:19], v[20:23]
    v_xor_b32 v8, s23, v8
    v_xor_b32 v5, s23, v5
    v_mfma_f32_16x16x32_bf16 v[44:47], a[148:151], a[20:23], v[44:47]
    v_xor_b32 v6, s23, v6
    v_xor_b32 v4, s23, v4
    v_mfma_f32_16x16x32_bf16 v[44:47], a[152:155], a[24:27], v[44:47]
    s_xor_b32 s23, s23, 0x8000
    v_exp_f32 v42, v42
    v_mfma_f32_16x16x32_bf16 v[44:47], a[156:159], a[28:31], v[44:47]
    s_and_b32 m0, s21, 0xffff
    v_exp_f32 v43, v43
    v_mfma_f32_16x16x32_bf16 v[64:67], a[192:195], v[60:63], v[64:67]
    ds_read_b128 a[96:99], v4 offset:0
    v_cvt_pk_bf16_f32 v57, v42, v43
    v_mfma_f32_16x16x32_bf16 v[68:71], a[196:199], v[60:63], v[68:71]
    v_exp_f32 v40, v40
    v_mfma_f32_16x16x32_bf16 v[72:75], a[200:203], v[60:63], v[72:75]
    v_exp_f32 v46, v46
    v_mfma_f32_16x16x32_bf16 v[76:79], a[204:207], v[60:63], v[76:79]
    v_exp_f32 v45, v45
    v_mfma_f32_16x16x32_bf16 v[80:83], a[208:211], v[60:63], v[80:83]
    v_exp_f32 v47, v47
    v_mfma_f32_16x16x32_bf16 v[84:87], a[212:215], v[60:63], v[84:87]
    v_exp_f32 v44, v44
    v_mfma_f32_16x16x32_bf16 v[88:91], a[216:219], v[60:63], v[88:91]
    v_cvt_pk_bf16_f32 v59, v46, v47
    v_cvt_pk_bf16_f32 v58, v44, v45
    v_mfma_f32_16x16x32_bf16 v[92:95], a[220:223], v[60:63], v[92:95]
    v_exp_f32 v41, v41
    v_mfma_f32_16x16x32_bf16 a[224:227], a[248:251], v[60:63], a[224:227]
    buffer_load_dwordx4 v234, s[8:11], s21 offen offset:0 nt lds
    v_mfma_f32_16x16x32_bf16 v[48:51], a[128:131], a[32:35], v[24:27]
    ds_read_b128 a[100:103], v5 offset:0
    v_cvt_pk_bf16_f32 v56, v40, v41
    v_mfma_f32_16x16x32_bf16 v[48:51], a[132:135], a[36:39], v[48:51]
    buffer_load_dwordx4 v3, s[8:11], s21 offen offset:1024 nt lds
    v_mfma_f32_16x16x32_bf16 v[48:51], a[136:139], a[40:43], v[48:51]
    ds_read_b128 a[104:107], v6 offset:0
    v_mfma_f32_16x16x32_bf16 v[48:51], a[140:143], a[44:47], v[48:51]
    ds_read_b128 a[108:111], v7 offset:0
    v_mfma_f32_16x16x32_bf16 v[52:55], a[144:147], a[32:35], v[24:27]
    buffer_load_dwordx4 v234, s[8:11], s21 offen offset:2048 nt lds
    v_mfma_f32_16x16x32_bf16 v[52:55], a[148:151], a[36:39], v[52:55]
    ds_read_b128 a[112:115], v4 offset:4096
    v_mfma_f32_16x16x32_bf16 v[52:55], a[152:155], a[40:43], v[52:55]
    buffer_load_dwordx4 v3, s[8:11], s21 offen offset:3072 nt lds
    v_mfma_f32_16x16x32_bf16 v[52:55], a[156:159], a[44:47], v[52:55]
    s_bitset1_b32 m0, 16
    v_exp_f32 v48, v48
    v_mfma_f32_16x16x32_bf16 v[96:99], a[192:195], v[56:59], v[96:99]
    v_exp_f32 v51, v51
    v_mfma_f32_16x16x32_bf16 v[100:103], a[196:199], v[56:59], v[100:103]
    v_exp_f32 v49, v49
    v_mfma_f32_16x16x32_bf16 v[104:107], a[200:203], v[56:59], v[104:107]
    ds_read_b128 a[116:119], v5 offset:4096
    v_cvt_pk_bf16_f32 v60, v48, v49
    v_mfma_f32_16x16x32_bf16 v[108:111], a[204:207], v[56:59], v[108:111]
    v_exp_f32 v53, v53
    v_mfma_f32_16x16x32_bf16 v[112:115], a[208:211], v[56:59], v[112:115]
    v_exp_f32 v52, v52
    v_mfma_f32_16x16x32_bf16 v[116:119], a[212:215], v[56:59], v[116:119]
    ds_read_b128 a[120:123], v6 offset:4096
    v_cvt_pk_bf16_f32 v62, v52, v53
    v_mfma_f32_16x16x32_bf16 v[120:123], a[216:219], v[56:59], v[120:123]
    v_exp_f32 v50, v50
    v_mfma_f32_16x16x32_bf16 v[124:127], a[220:223], v[56:59], v[124:127]
    v_exp_f32 v54, v54
    v_mfma_f32_16x16x32_bf16 a[228:231], a[248:251], v[56:59], a[228:231]
    v_exp_f32 v55, v55
    v_mfma_f32_16x16x32_bf16 v[40:43], a[128:131], a[48:51], v[28:31]
    v_cvt_pk_bf16_f32 v61, v50, v51
    v_cvt_pk_bf16_f32 v63, v54, v55
    v_mfma_f32_16x16x32_bf16 v[40:43], a[132:135], a[52:55], v[40:43]
    buffer_load_dwordx4 v234, s[12:15], s21 offen offset:0 nt lds
    v_mfma_f32_16x16x32_bf16 v[40:43], a[136:139], a[56:59], v[40:43]
    ds_read_b128 a[124:127], v7 offset:4096
    v_mfma_f32_16x16x32_bf16 v[40:43], a[140:143], a[60:63], v[40:43]
    buffer_load_dwordx4 v3, s[12:15], s21 offen offset:1024 nt lds
    v_mfma_f32_16x16x32_bf16 v[44:47], a[144:147], a[48:51], v[28:31]
    ds_read_b64_tr_b16 a[160:161], v8 offset:0
    v_mfma_f32_16x16x32_bf16 v[44:47], a[148:151], a[52:55], v[44:47]
    buffer_load_dwordx4 v234, s[12:15], s21 offen offset:2048 nt lds
    v_mfma_f32_16x16x32_bf16 v[44:47], a[152:155], a[56:59], v[44:47]
    ds_read_b64_tr_b16 a[162:163], v8 offset:4096
    v_mfma_f32_16x16x32_bf16 v[44:47], a[156:159], a[60:63], v[44:47]
    v_exp_f32 v42, v42
    v_mfma_f32_16x16x32_bf16 v[128:131], a[192:195], v[60:63], v[128:131]
    v_exp_f32 v43, v43
    v_mfma_f32_16x16x32_bf16 v[132:135], a[196:199], v[60:63], v[132:135]
    ds_read_b64_tr_b16 a[164:165], v8 offset:8
    v_cvt_pk_bf16_f32 v57, v42, v43
    v_mfma_f32_16x16x32_bf16 v[136:139], a[200:203], v[60:63], v[136:139]
    buffer_load_dwordx4 v3, s[12:15], s21 offen offset:3072 nt lds
    v_mfma_f32_16x16x32_bf16 v[140:143], a[204:207], v[60:63], v[140:143]
    s_add_u32 s21, s21, 4096
    v_exp_f32 v44, v44
    v_mfma_f32_16x16x32_bf16 v[144:147], a[208:211], v[60:63], v[144:147]
    s_and_b32 m0, s21, 0xffff
    v_exp_f32 v46, v46
    v_mfma_f32_16x16x32_bf16 v[148:151], a[212:215], v[60:63], v[148:151]
    s_waitcnt lgkmcnt(3)
    v_exp_f32 v47, v47
    v_mfma_f32_16x16x32_bf16 v[152:155], a[216:219], v[60:63], v[152:155]
    ds_read_b64_tr_b16 a[166:167], v8 offset:4104
    v_cvt_pk_bf16_f32 v59, v46, v47
    v_mfma_f32_16x16x32_bf16 v[156:159], a[220:223], v[60:63], v[156:159]
    v_exp_f32 v40, v40
    v_mfma_f32_16x16x32_bf16 a[232:235], a[248:251], v[60:63], a[232:235]
    v_exp_f32 v45, v45
    v_mfma_f32_16x16x32_bf16 v[48:51], a[128:131], a[64:67], v[32:35]
    ds_read_b64_tr_b16 a[168:169], v9 offset:0
    v_cvt_pk_bf16_f32 v58, v44, v45
    v_mfma_f32_16x16x32_bf16 v[48:51], a[132:135], a[68:71], v[48:51]
    v_exp_f32 v41, v41
    v_mfma_f32_16x16x32_bf16 v[48:51], a[136:139], a[72:75], v[48:51]
    buffer_load_dwordx4 v234, s[8:11], s21 offen offset:0 nt lds
    v_mfma_f32_16x16x32_bf16 v[48:51], a[140:143], a[76:79], v[48:51]
    ds_read_b64_tr_b16 a[170:171], v9 offset:4096
    v_cvt_pk_bf16_f32 v56, v40, v41
    v_mfma_f32_16x16x32_bf16 v[52:55], a[144:147], a[64:67], v[32:35]
    buffer_load_dwordx4 v3, s[8:11], s21 offen offset:1024 nt lds
    v_mfma_f32_16x16x32_bf16 v[52:55], a[148:151], a[68:71], v[52:55]
    ds_read_b64_tr_b16 a[172:173], v9 offset:8
    v_mfma_f32_16x16x32_bf16 v[52:55], a[152:155], a[72:75], v[52:55]
    ds_read_b64_tr_b16 a[174:175], v9 offset:4104
    v_mfma_f32_16x16x32_bf16 v[52:55], a[156:159], a[76:79], v[52:55]
    buffer_load_dwordx4 v234, s[8:11], s21 offen offset:2048 nt lds
    v_mfma_f32_16x16x32_bf16 v[160:163], a[192:195], v[56:59], v[160:163]
    v_exp_f32 v50, v50
    v_mfma_f32_16x16x32_bf16 v[164:167], a[196:199], v[56:59], v[164:167]
    v_exp_f32 v48, v48
    v_mfma_f32_16x16x32_bf16 v[168:171], a[200:203], v[56:59], v[168:171]
    v_exp_f32 v49, v49
    v_mfma_f32_16x16x32_bf16 v[172:175], a[204:207], v[56:59], v[172:175]
    ds_read_b64_tr_b16 a[176:177], v10 offset:0
    v_cvt_pk_bf16_f32 v60, v48, v49
    v_mfma_f32_16x16x32_bf16 v[176:179], a[208:211], v[56:59], v[176:179]
    buffer_load_dwordx4 v3, s[8:11], s21 offen offset:3072 nt lds
    v_mfma_f32_16x16x32_bf16 v[180:183], a[212:215], v[56:59], v[180:183]
    s_bitset1_b32 m0, 16
    v_exp_f32 v52, v52
    v_mfma_f32_16x16x32_bf16 v[184:187], a[216:219], v[56:59], v[184:187]
    v_exp_f32 v54, v54
    v_mfma_f32_16x16x32_bf16 v[188:191], a[220:223], v[56:59], v[188:191]
    v_exp_f32 v53, v53
    v_mfma_f32_16x16x32_bf16 a[236:239], a[248:251], v[56:59], a[236:239]
    ds_read_b64_tr_b16 a[178:179], v10 offset:4096
    v_cvt_pk_bf16_f32 v62, v52, v53
    v_mfma_f32_16x16x32_bf16 v[40:43], a[96:99], a[0:3], v[16:19]
    v_exp_f32 v55, v55
    v_mfma_f32_16x16x32_bf16 v[40:43], a[100:103], a[4:7], v[40:43]
    ds_read_b64_tr_b16 a[180:181], v10 offset:8
    v_cvt_pk_bf16_f32 v63, v54, v55
    v_mfma_f32_16x16x32_bf16 v[40:43], a[104:107], a[8:11], v[40:43]
    buffer_load_dwordx4 v234, s[12:15], s21 offen offset:0 nt lds
    v_mfma_f32_16x16x32_bf16 v[40:43], a[108:111], a[12:15], v[40:43]
    v_exp_f32 v51, v51
    v_mfma_f32_16x16x32_bf16 v[44:47], a[112:115], a[0:3], v[16:19]
    ds_read_b64_tr_b16 a[182:183], v10 offset:4104
    v_cvt_pk_bf16_f32 v61, v50, v51
    v_mfma_f32_16x16x32_bf16 v[44:47], a[116:119], a[4:7], v[44:47]
    buffer_load_dwordx4 v3, s[12:15], s21 offen offset:1024 nt lds
    v_mfma_f32_16x16x32_bf16 v[44:47], a[120:123], a[8:11], v[44:47]
    ds_read_b64_tr_b16 a[184:185], v11 offset:0
    v_mfma_f32_16x16x32_bf16 v[44:47], a[124:127], a[12:15], v[44:47]
    buffer_load_dwordx4 v234, s[12:15], s21 offen offset:2048 nt lds
    ds_read_b64_tr_b16 a[186:187], v11 offset:4096
    ds_read_b64_tr_b16 a[188:189], v11 offset:8
    buffer_load_dwordx4 v3, s[12:15], s21 offen offset:3072 nt lds
    s_add_u32 s21, s21, 4096
    ds_read_b64_tr_b16 a[190:191], v11 offset:4104
    s_sub_u32 s22, s22, 1
    s_cmp_lg_u32 s22, 0
    s_cbranch_scc1 L_loop5
    v_mfma_f32_16x16x32_bf16 v[192:195], a[192:195], v[60:63], v[192:195]
    s_waitcnt vmcnt(32)
    s_barrier
    v_mfma_f32_16x16x32_bf16 v[196:199], a[196:199], v[60:63], v[196:199]
    ds_read_b128 a[128:131], v4 offset:8192
    v_mov_b32 v15, 0
    v_mfma_f32_16x16x32_bf16 v[200:203], a[200:203], v[60:63], v[200:203]
    ds_read_b128 a[132:135], v5 offset:8192
    v_accvgpr_read_b32 v3, a252
    v_mfma_f32_16x16x32_bf16 v[204:207], a[204:207], v[60:63], v[204:207]
    ds_read_b128 a[136:139], v6 offset:8192
    ds_read_b128 a[140:143], v7 offset:8192
    v_mfma_f32_16x16x32_bf16 v[208:211], a[208:211], v[60:63], v[208:211]
    ds_read_b128 a[144:147], v4 offset:12288
    ds_read_b128 a[148:151], v5 offset:12288
    v_mfma_f32_16x16x32_bf16 v[212:215], a[212:215], v[60:63], v[212:215]
    ds_read_b128 a[152:155], v6 offset:12288
    v_mfma_f32_16x16x32_bf16 v[216:219], a[216:219], v[60:63], v[216:219]
    ds_read_b128 a[156:159], v7 offset:12288
    v_mfma_f32_16x16x32_bf16 v[220:223], a[220:223], v[60:63], v[220:223]
    ds_read_b64_tr_b16 a[192:193], v8 offset:8192
    v_mfma_f32_16x16x32_bf16 a[240:243], a[248:251], v[60:63], a[240:243]
    ds_read_b64_tr_b16 a[194:195], v8 offset:12288
    s_waitcnt lgkmcnt(9)
    v_mfma_f32_16x16x32_bf16 v[48:51], a[128:131], a[0:3], v[16:19]
    ds_read_b64_tr_b16 a[196:197], v8 offset:8200
    s_waitcnt lgkmcnt(9)
    v_mfma_f32_16x16x32_bf16 v[48:51], a[132:135], a[4:7], v[48:51]
    ds_read_b64_tr_b16 a[198:199], v8 offset:12296
    s_waitcnt lgkmcnt(9)
    v_mfma_f32_16x16x32_bf16 v[48:51], a[136:139], a[8:11], v[48:51]
    ds_read_b64_tr_b16 a[200:201], v9 offset:8192
    s_waitcnt lgkmcnt(9)
    v_mfma_f32_16x16x32_bf16 v[48:51], a[140:143], a[12:15], v[48:51]
    ds_read_b64_tr_b16 a[202:203], v9 offset:12288
    v_exp_f32 v40, v40
    s_waitcnt lgkmcnt(9)
    v_mfma_f32_16x16x32_bf16 v[52:55], a[144:147], a[0:3], v[16:19]
    ds_read_b64_tr_b16 a[204:205], v9 offset:8200
    v_exp_f32 v41, v41
    s_waitcnt lgkmcnt(8)
    v_mfma_f32_16x16x32_bf16 v[52:55], a[148:151], a[4:7], v[52:55]
    ds_read_b64_tr_b16 a[206:207], v9 offset:12296
    v_cvt_pk_bf16_f32 v56, v40, v41
    v_mfma_f32_16x16x32_bf16 v[52:55], a[152:155], a[8:11], v[52:55]
    ds_read_b64_tr_b16 a[208:209], v10 offset:8192
    v_exp_f32 v42, v42
    s_waitcnt lgkmcnt(7)
    v_mfma_f32_16x16x32_bf16 v[52:55], a[156:159], a[12:15], v[52:55]
    ds_read_b64_tr_b16 a[210:211], v10 offset:12288
    v_exp_f32 v43, v43
    v_exp_f32 v44, v44
    v_exp_f32 v45, v45
    v_exp_f32 v46, v46
    v_exp_f32 v47, v47
    v_cvt_pk_bf16_f32 v57, v42, v43
    v_cvt_pk_bf16_f32 v58, v44, v45
    v_cvt_pk_bf16_f32 v59, v46, v47
    v_exp_f32 v48, v48
    s_nop 0
    v_mfma_f32_16x16x32_bf16 a[224:227], a[248:251], v[56:59], a[224:227]
    ds_read_b64_tr_b16 a[212:213], v10 offset:8200
    v_mfma_f32_16x16x32_bf16 v[64:67], a[160:163], v[56:59], v[64:67]
    ds_read_b64_tr_b16 a[214:215], v10 offset:12296
    v_mfma_f32_16x16x32_bf16 v[68:71], a[164:167], v[56:59], v[68:71]
    ds_read_b64_tr_b16 a[216:217], v11 offset:8192
    v_mfma_f32_16x16x32_bf16 v[72:75], a[168:171], v[56:59], v[72:75]
    ds_read_b64_tr_b16 a[218:219], v11 offset:12288
    v_mfma_f32_16x16x32_bf16 v[76:79], a[172:175], v[56:59], v[76:79]
    ds_read_b64_tr_b16 a[220:221], v11 offset:8200
    v_mfma_f32_16x16x32_bf16 v[80:83], a[176:179], v[56:59], v[80:83]
    ds_read_b64_tr_b16 a[222:223], v11 offset:12296
    v_mfma_f32_16x16x32_bf16 v[84:87], a[180:183], v[56:59], v[84:87]
    s_mov_b32 vcc_lo, 0x55555555
    v_exp_f32 v49, v49
    v_mfma_f32_16x16x32_bf16 v[88:91], a[184:187], v[56:59], v[88:91]
    s_mov_b32 vcc_hi, 0x55555555
    v_exp_f32 v50, v50
    v_mfma_f32_16x16x32_bf16 v[92:95], a[188:191], v[56:59], v[92:95]
    s_mul_i32 s29, s20, 24576
    v_exp_f32 v51, v51
    v_mfma_f32_16x16x32_bf16 v[40:43], a[96:99], a[16:19], v[20:23]
    v_exp_f32 v52, v52
    v_mfma_f32_16x16x32_bf16 v[40:43], a[100:103], a[20:23], v[40:43]
    v_exp_f32 v53, v53
    v_mfma_f32_16x16x32_bf16 v[40:43], a[104:107], a[24:27], v[40:43]
    v_exp_f32 v54, v54
    v_mfma_f32_16x16x32_bf16 v[40:43], a[108:111], a[28:31], v[40:43]
    v_exp_f32 v55, v55
    v_mfma_f32_16x16x32_bf16 v[44:47], a[112:115], a[16:19], v[20:23]
    v_cvt_pk_bf16_f32 v60, v48, v49
    v_cvt_pk_bf16_f32 v61, v50, v51
    v_mfma_f32_16x16x32_bf16 v[44:47], a[116:119], a[20:23], v[44:47]
    v_cvt_pk_bf16_f32 v62, v52, v53
    v_cvt_pk_bf16_f32 v63, v54, v55
    v_mfma_f32_16x16x32_bf16 v[44:47], a[120:123], a[24:27], v[44:47]
    v_exp_f32 v40, v40
    v_mfma_f32_16x16x32_bf16 v[44:47], a[124:127], a[28:31], v[44:47]
    v_exp_f32 v41, v41
    v_mfma_f32_16x16x32_bf16 a[224:227], a[248:251], v[60:63], a[224:227]
    v_exp_f32 v42, v42
    v_mfma_f32_16x16x32_bf16 v[64:67], a[192:195], v[60:63], v[64:67]
    v_exp_f32 v43, v43
    s_waitcnt lgkmcnt(0)
    v_mfma_f32_16x16x32_bf16 v[68:71], a[196:199], v[60:63], v[68:71]
    v_cvt_pk_bf16_f32 v56, v40, v41
    v_cvt_pk_bf16_f32 v57, v42, v43
    v_mfma_f32_16x16x32_bf16 v[72:75], a[200:203], v[60:63], v[72:75]
    v_exp_f32 v44, v44
    v_mfma_f32_16x16x32_bf16 v[76:79], a[204:207], v[60:63], v[76:79]
    v_accvgpr_read_b32 v16, a224
    v_add_f32 v15, v15, v16
    v_mfma_f32_16x16x32_bf16 v[80:83], a[208:211], v[60:63], v[80:83]
    v_rcp_f32 v16, v16
    v_mfma_f32_16x16x32_bf16 v[84:87], a[212:215], v[60:63], v[84:87]
    v_mul_f32 v17, s34, v16
    v_mfma_f32_16x16x32_bf16 v[88:91], a[216:219], v[60:63], v[88:91]
    v_exp_f32 v45, v45
    v_mfma_f32_16x16x32_bf16 v[92:95], a[220:223], v[60:63], v[92:95]
    v_exp_f32 v46, v46
    v_exp_f32 v47, v47
    v_cvt_pk_bf16_f32 v58, v44, v45
    v_cvt_pk_bf16_f32 v59, v46, v47
    v_pk_fma_f32 v[64:65], v[64:65], v[16:17], v[16:17] op_sel:[0,0,1] op_sel_hi:[1,0,1] neg_lo:[0,0,1] neg_hi:[0,0,1]
    v_pk_fma_f32 v[66:67], v[66:67], v[16:17], v[16:17] op_sel:[0,0,1] op_sel_hi:[1,0,1] neg_lo:[0,0,1] neg_hi:[0,0,1]
    v_pk_fma_f32 v[68:69], v[68:69], v[16:17], v[16:17] op_sel:[0,0,1] op_sel_hi:[1,0,1] neg_lo:[0,0,1] neg_hi:[0,0,1]
    v_pk_fma_f32 v[70:71], v[70:71], v[16:17], v[16:17] op_sel:[0,0,1] op_sel_hi:[1,0,1] neg_lo:[0,0,1] neg_hi:[0,0,1]
    v_pk_fma_f32 v[72:73], v[72:73], v[16:17], v[16:17] op_sel:[0,0,1] op_sel_hi:[1,0,1] neg_lo:[0,0,1] neg_hi:[0,0,1]
    v_pk_fma_f32 v[74:75], v[74:75], v[16:17], v[16:17] op_sel:[0,0,1] op_sel_hi:[1,0,1] neg_lo:[0,0,1] neg_hi:[0,0,1]
    v_pk_fma_f32 v[76:77], v[76:77], v[16:17], v[16:17] op_sel:[0,0,1] op_sel_hi:[1,0,1] neg_lo:[0,0,1] neg_hi:[0,0,1]
    v_pk_fma_f32 v[78:79], v[78:79], v[16:17], v[16:17] op_sel:[0,0,1] op_sel_hi:[1,0,1] neg_lo:[0,0,1] neg_hi:[0,0,1]
    v_pk_fma_f32 v[80:81], v[80:81], v[16:17], v[16:17] op_sel:[0,0,1] op_sel_hi:[1,0,1] neg_lo:[0,0,1] neg_hi:[0,0,1]
    v_pk_fma_f32 v[82:83], v[82:83], v[16:17], v[16:17] op_sel:[0,0,1] op_sel_hi:[1,0,1] neg_lo:[0,0,1] neg_hi:[0,0,1]
    v_pk_fma_f32 v[84:85], v[84:85], v[16:17], v[16:17] op_sel:[0,0,1] op_sel_hi:[1,0,1] neg_lo:[0,0,1] neg_hi:[0,0,1]
    v_pk_fma_f32 v[86:87], v[86:87], v[16:17], v[16:17] op_sel:[0,0,1] op_sel_hi:[1,0,1] neg_lo:[0,0,1] neg_hi:[0,0,1]
    v_pk_fma_f32 v[88:89], v[88:89], v[16:17], v[16:17] op_sel:[0,0,1] op_sel_hi:[1,0,1] neg_lo:[0,0,1] neg_hi:[0,0,1]
    v_pk_fma_f32 v[90:91], v[90:91], v[16:17], v[16:17] op_sel:[0,0,1] op_sel_hi:[1,0,1] neg_lo:[0,0,1] neg_hi:[0,0,1]
    v_pk_fma_f32 v[92:93], v[92:93], v[16:17], v[16:17] op_sel:[0,0,1] op_sel_hi:[1,0,1] neg_lo:[0,0,1] neg_hi:[0,0,1]
    v_pk_fma_f32 v[94:95], v[94:95], v[16:17], v[16:17] op_sel:[0,0,1] op_sel_hi:[1,0,1] neg_lo:[0,0,1] neg_hi:[0,0,1]
    v_cvt_pk_bf16_f32 v64, v64, v65
    v_cvt_pk_bf16_f32 v72, v72, v73
    v_cvt_pk_bf16_f32 v65, v66, v67
    v_cvt_pk_bf16_f32 v73, v74, v75
    v_cvt_pk_bf16_f32 v66, v68, v69
    v_cvt_pk_bf16_f32 v67, v70, v71
    v_cvt_pk_bf16_f32 v74, v76, v77
    v_cvt_pk_bf16_f32 v75, v78, v79
    v_cndmask_b32_dpp v68, v72, v64, vcc quad_perm:[1,0,3,2] row_mask:0xf bank_mask:0xf
    v_cndmask_b32_dpp v70, v74, v66, vcc quad_perm:[1,0,3,2] row_mask:0xf bank_mask:0xf
    v_cvt_pk_bf16_f32 v80, v80, v81
    v_cvt_pk_bf16_f32 v88, v88, v89
    v_cndmask_b32_dpp v69, v73, v65, vcc quad_perm:[1,0,3,2] row_mask:0xf bank_mask:0xf
    v_cndmask_b32_dpp v71, v75, v67, vcc quad_perm:[1,0,3,2] row_mask:0xf bank_mask:0xf
    buffer_store_dwordx4 v[68:71], v3, s[16:19], s29 offen offset:0 sc0 sc1 nt
    s_not_b64 vcc, vcc
    v_cvt_pk_bf16_f32 v81, v82, v83
    v_cvt_pk_bf16_f32 v89, v90, v91
    v_cndmask_b32_dpp v72, v64, v72, vcc quad_perm:[1,0,3,2] row_mask:0xf bank_mask:0xf
    v_cndmask_b32_dpp v73, v65, v73, vcc quad_perm:[1,0,3,2] row_mask:0xf bank_mask:0xf
    v_cvt_pk_bf16_f32 v82, v84, v85
    v_cvt_pk_bf16_f32 v83, v86, v87
    v_cndmask_b32_dpp v74, v66, v74, vcc quad_perm:[1,0,3,2] row_mask:0xf bank_mask:0xf
    v_cndmask_b32_dpp v75, v67, v75, vcc quad_perm:[1,0,3,2] row_mask:0xf bank_mask:0xf
    buffer_store_dwordx4 v[72:75], v3, s[16:19], s29 offen offset:256 sc0 sc1 nt
    v_cvt_pk_bf16_f32 v90, v92, v93
    v_cvt_pk_bf16_f32 v91, v94, v95
    s_not_b64 vcc, vcc
    v_cndmask_b32_dpp v84, v88, v80, vcc quad_perm:[1,0,3,2] row_mask:0xf bank_mask:0xf
    v_cndmask_b32_dpp v86, v90, v82, vcc quad_perm:[1,0,3,2] row_mask:0xf bank_mask:0xf
    v_cndmask_b32_dpp v85, v89, v81, vcc quad_perm:[1,0,3,2] row_mask:0xf bank_mask:0xf
    v_cndmask_b32_dpp v87, v91, v83, vcc quad_perm:[1,0,3,2] row_mask:0xf bank_mask:0xf
    buffer_store_dwordx4 v[84:87], v3, s[16:19], s29 offen offset:128 sc0 sc1 nt
    s_not_b64 vcc, vcc
    v_cndmask_b32_dpp v88, v80, v88, vcc quad_perm:[1,0,3,2] row_mask:0xf bank_mask:0xf
    v_cndmask_b32_dpp v89, v81, v89, vcc quad_perm:[1,0,3,2] row_mask:0xf bank_mask:0xf
    v_cndmask_b32_dpp v90, v82, v90, vcc quad_perm:[1,0,3,2] row_mask:0xf bank_mask:0xf
    v_cndmask_b32_dpp v91, v83, v91, vcc quad_perm:[1,0,3,2] row_mask:0xf bank_mask:0xf
    buffer_store_dwordx4 v[88:91], v3, s[16:19], s29 offen offset:384 sc0 sc1 nt
    s_not_b64 vcc, vcc
    s_add_u32 s29, s29, 4096
    v_mfma_f32_16x16x32_bf16 v[48:51], a[128:131], a[16:19], v[20:23]
    v_mfma_f32_16x16x32_bf16 v[48:51], a[132:135], a[20:23], v[48:51]
    v_mfma_f32_16x16x32_bf16 v[48:51], a[136:139], a[24:27], v[48:51]
    v_mfma_f32_16x16x32_bf16 v[48:51], a[140:143], a[28:31], v[48:51]
    v_mfma_f32_16x16x32_bf16 v[52:55], a[144:147], a[16:19], v[20:23]
    v_mfma_f32_16x16x32_bf16 v[52:55], a[148:151], a[20:23], v[52:55]
    v_mfma_f32_16x16x32_bf16 v[52:55], a[152:155], a[24:27], v[52:55]
    v_mfma_f32_16x16x32_bf16 v[52:55], a[156:159], a[28:31], v[52:55]
    v_mfma_f32_16x16x32_bf16 a[228:231], a[248:251], v[56:59], a[228:231]
    v_mfma_f32_16x16x32_bf16 v[96:99], a[160:163], v[56:59], v[96:99]
    v_mfma_f32_16x16x32_bf16 v[100:103], a[164:167], v[56:59], v[100:103]
    s_nop 0
    v_exp_f32 v48, v48
    v_mfma_f32_16x16x32_bf16 v[104:107], a[168:171], v[56:59], v[104:107]
    v_exp_f32 v49, v49
    v_mfma_f32_16x16x32_bf16 v[108:111], a[172:175], v[56:59], v[108:111]
    v_exp_f32 v50, v50
    v_mfma_f32_16x16x32_bf16 v[112:115], a[176:179], v[56:59], v[112:115]
    v_exp_f32 v51, v51
    v_mfma_f32_16x16x32_bf16 v[116:119], a[180:183], v[56:59], v[116:119]
    v_exp_f32 v52, v52
    v_mfma_f32_16x16x32_bf16 v[120:123], a[184:187], v[56:59], v[120:123]
    v_exp_f32 v53, v53
    v_mfma_f32_16x16x32_bf16 v[124:127], a[188:191], v[56:59], v[124:127]
    v_exp_f32 v54, v54
    v_mfma_f32_16x16x32_bf16 v[40:43], a[96:99], a[32:35], v[24:27]
    v_exp_f32 v55, v55
    v_mfma_f32_16x16x32_bf16 v[40:43], a[100:103], a[36:39], v[40:43]
    v_cvt_pk_bf16_f32 v60, v48, v49
    v_cvt_pk_bf16_f32 v61, v50, v51
    v_mfma_f32_16x16x32_bf16 v[40:43], a[104:107], a[40:43], v[40:43]
    v_cvt_pk_bf16_f32 v62, v52, v53
    v_cvt_pk_bf16_f32 v63, v54, v55
    v_mfma_f32_16x16x32_bf16 v[40:43], a[108:111], a[44:47], v[40:43]
    v_mfma_f32_16x16x32_bf16 v[44:47], a[112:115], a[32:35], v[24:27]
    v_mfma_f32_16x16x32_bf16 v[44:47], a[116:119], a[36:39], v[44:47]
    v_mfma_f32_16x16x32_bf16 v[44:47], a[120:123], a[40:43], v[44:47]
    v_mfma_f32_16x16x32_bf16 v[44:47], a[124:127], a[44:47], v[44:47]
    v_mfma_f32_16x16x32_bf16 a[228:231], a[248:251], v[60:63], a[228:231]
    v_mfma_f32_16x16x32_bf16 v[96:99], a[192:195], v[60:63], v[96:99]
    v_mfma_f32_16x16x32_bf16 v[100:103], a[196:199], v[60:63], v[100:103]
    s_nop 0
    v_exp_f32 v40, v40
    v_mfma_f32_16x16x32_bf16 v[104:107], a[200:203], v[60:63], v[104:107]
    v_exp_f32 v41, v41
    v_mfma_f32_16x16x32_bf16 v[108:111], a[204:207], v[60:63], v[108:111]
    v_exp_f32 v42, v42
    v_mfma_f32_16x16x32_bf16 v[112:115], a[208:211], v[60:63], v[112:115]
    v_accvgpr_read_b32 v20, a228
    v_add_f32 v15, v15, v20
    v_mfma_f32_16x16x32_bf16 v[116:119], a[212:215], v[60:63], v[116:119]
    v_rcp_f32 v20, v20
    v_mfma_f32_16x16x32_bf16 v[120:123], a[216:219], v[60:63], v[120:123]
    v_mul_f32 v21, s34, v20
    v_cvt_pk_bf16_f32 v56, v40, v41
    v_mfma_f32_16x16x32_bf16 v[124:127], a[220:223], v[60:63], v[124:127]
    v_exp_f32 v43, v43
    v_mfma_f32_16x16x32_bf16 v[48:51], a[128:131], a[32:35], v[24:27]
    v_exp_f32 v44, v44
    v_mfma_f32_16x16x32_bf16 v[48:51], a[132:135], a[36:39], v[48:51]
    v_exp_f32 v45, v45
    v_mfma_f32_16x16x32_bf16 v[48:51], a[136:139], a[40:43], v[48:51]
    v_exp_f32 v46, v46
    v_mfma_f32_16x16x32_bf16 v[48:51], a[140:143], a[44:47], v[48:51]
    v_exp_f32 v47, v47
    v_pk_fma_f32 v[96:97], v[96:97], v[20:21], v[20:21] op_sel:[0,0,1] op_sel_hi:[1,0,1] neg_lo:[0,0,1] neg_hi:[0,0,1]
    v_pk_fma_f32 v[98:99], v[98:99], v[20:21], v[20:21] op_sel:[0,0,1] op_sel_hi:[1,0,1] neg_lo:[0,0,1] neg_hi:[0,0,1]
    v_pk_fma_f32 v[100:101], v[100:101], v[20:21], v[20:21] op_sel:[0,0,1] op_sel_hi:[1,0,1] neg_lo:[0,0,1] neg_hi:[0,0,1]
    v_pk_fma_f32 v[102:103], v[102:103], v[20:21], v[20:21] op_sel:[0,0,1] op_sel_hi:[1,0,1] neg_lo:[0,0,1] neg_hi:[0,0,1]
    v_pk_fma_f32 v[104:105], v[104:105], v[20:21], v[20:21] op_sel:[0,0,1] op_sel_hi:[1,0,1] neg_lo:[0,0,1] neg_hi:[0,0,1]
    v_pk_fma_f32 v[106:107], v[106:107], v[20:21], v[20:21] op_sel:[0,0,1] op_sel_hi:[1,0,1] neg_lo:[0,0,1] neg_hi:[0,0,1]
    v_pk_fma_f32 v[108:109], v[108:109], v[20:21], v[20:21] op_sel:[0,0,1] op_sel_hi:[1,0,1] neg_lo:[0,0,1] neg_hi:[0,0,1]
    v_pk_fma_f32 v[110:111], v[110:111], v[20:21], v[20:21] op_sel:[0,0,1] op_sel_hi:[1,0,1] neg_lo:[0,0,1] neg_hi:[0,0,1]
    v_pk_fma_f32 v[112:113], v[112:113], v[20:21], v[20:21] op_sel:[0,0,1] op_sel_hi:[1,0,1] neg_lo:[0,0,1] neg_hi:[0,0,1]
    v_pk_fma_f32 v[114:115], v[114:115], v[20:21], v[20:21] op_sel:[0,0,1] op_sel_hi:[1,0,1] neg_lo:[0,0,1] neg_hi:[0,0,1]
    v_pk_fma_f32 v[116:117], v[116:117], v[20:21], v[20:21] op_sel:[0,0,1] op_sel_hi:[1,0,1] neg_lo:[0,0,1] neg_hi:[0,0,1]
    v_pk_fma_f32 v[118:119], v[118:119], v[20:21], v[20:21] op_sel:[0,0,1] op_sel_hi:[1,0,1] neg_lo:[0,0,1] neg_hi:[0,0,1]
    v_pk_fma_f32 v[120:121], v[120:121], v[20:21], v[20:21] op_sel:[0,0,1] op_sel_hi:[1,0,1] neg_lo:[0,0,1] neg_hi:[0,0,1]
    v_pk_fma_f32 v[122:123], v[122:123], v[20:21], v[20:21] op_sel:[0,0,1] op_sel_hi:[1,0,1] neg_lo:[0,0,1] neg_hi:[0,0,1]
    v_pk_fma_f32 v[124:125], v[124:125], v[20:21], v[20:21] op_sel:[0,0,1] op_sel_hi:[1,0,1] neg_lo:[0,0,1] neg_hi:[0,0,1]
    v_pk_fma_f32 v[126:127], v[126:127], v[20:21], v[20:21] op_sel:[0,0,1] op_sel_hi:[1,0,1] neg_lo:[0,0,1] neg_hi:[0,0,1]
    v_mfma_f32_16x16x32_bf16 v[52:55], a[144:147], a[32:35], v[24:27]
    v_cvt_pk_bf16_f32 v96, v96, v97
    v_cvt_pk_bf16_f32 v104, v104, v105
    v_mfma_f32_16x16x32_bf16 v[52:55], a[148:151], a[36:39], v[52:55]
    v_cvt_pk_bf16_f32 v97, v98, v99
    v_cvt_pk_bf16_f32 v105, v106, v107
    v_mfma_f32_16x16x32_bf16 v[52:55], a[152:155], a[40:43], v[52:55]
    v_cvt_pk_bf16_f32 v98, v100, v101
    v_cvt_pk_bf16_f32 v99, v102, v103
    v_mfma_f32_16x16x32_bf16 v[52:55], a[156:159], a[44:47], v[52:55]
    v_cvt_pk_bf16_f32 v106, v108, v109
    v_cvt_pk_bf16_f32 v107, v110, v111
    v_cndmask_b32_dpp v100, v104, v96, vcc quad_perm:[1,0,3,2] row_mask:0xf bank_mask:0xf
    v_cndmask_b32_dpp v102, v106, v98, vcc quad_perm:[1,0,3,2] row_mask:0xf bank_mask:0xf
    v_cvt_pk_bf16_f32 v112, v112, v113
    v_cvt_pk_bf16_f32 v120, v120, v121
    v_cndmask_b32_dpp v101, v105, v97, vcc quad_perm:[1,0,3,2] row_mask:0xf bank_mask:0xf
    v_cndmask_b32_dpp v103, v107, v99, vcc quad_perm:[1,0,3,2] row_mask:0xf bank_mask:0xf
    buffer_store_dwordx4 v[100:103], v3, s[16:19], s29 offen offset:0 sc0 sc1 nt
    s_not_b64 vcc, vcc
    v_cvt_pk_bf16_f32 v113, v114, v115
    v_cvt_pk_bf16_f32 v121, v122, v123
    v_cndmask_b32_dpp v104, v96, v104, vcc quad_perm:[1,0,3,2] row_mask:0xf bank_mask:0xf
    v_cndmask_b32_dpp v105, v97, v105, vcc quad_perm:[1,0,3,2] row_mask:0xf bank_mask:0xf
    v_cvt_pk_bf16_f32 v114, v116, v117
    v_cvt_pk_bf16_f32 v115, v118, v119
    v_cndmask_b32_dpp v106, v98, v106, vcc quad_perm:[1,0,3,2] row_mask:0xf bank_mask:0xf
    v_cndmask_b32_dpp v107, v99, v107, vcc quad_perm:[1,0,3,2] row_mask:0xf bank_mask:0xf
    buffer_store_dwordx4 v[104:107], v3, s[16:19], s29 offen offset:256 sc0 sc1 nt
    v_cvt_pk_bf16_f32 v122, v124, v125
    v_cvt_pk_bf16_f32 v123, v126, v127
    s_not_b64 vcc, vcc
    v_cndmask_b32_dpp v116, v120, v112, vcc quad_perm:[1,0,3,2] row_mask:0xf bank_mask:0xf
    v_cndmask_b32_dpp v118, v122, v114, vcc quad_perm:[1,0,3,2] row_mask:0xf bank_mask:0xf
    v_cvt_pk_bf16_f32 v57, v42, v43
    v_cvt_pk_bf16_f32 v58, v44, v45
    v_cndmask_b32_dpp v117, v121, v113, vcc quad_perm:[1,0,3,2] row_mask:0xf bank_mask:0xf
    v_cndmask_b32_dpp v119, v123, v115, vcc quad_perm:[1,0,3,2] row_mask:0xf bank_mask:0xf
    buffer_store_dwordx4 v[116:119], v3, s[16:19], s29 offen offset:128 sc0 sc1 nt
    s_not_b64 vcc, vcc
    v_cvt_pk_bf16_f32 v59, v46, v47
    v_exp_f32 v48, v48
    v_cndmask_b32_dpp v120, v112, v120, vcc quad_perm:[1,0,3,2] row_mask:0xf bank_mask:0xf
    v_cndmask_b32_dpp v121, v113, v121, vcc quad_perm:[1,0,3,2] row_mask:0xf bank_mask:0xf
    v_exp_f32 v49, v49
    v_exp_f32 v50, v50
    v_cndmask_b32_dpp v122, v114, v122, vcc quad_perm:[1,0,3,2] row_mask:0xf bank_mask:0xf
    v_cndmask_b32_dpp v123, v115, v123, vcc quad_perm:[1,0,3,2] row_mask:0xf bank_mask:0xf
    buffer_store_dwordx4 v[120:123], v3, s[16:19], s29 offen offset:384 sc0 sc1 nt
    s_not_b64 vcc, vcc
    s_add_u32 s29, s29, 4096
    v_mfma_f32_16x16x32_bf16 a[232:235], a[248:251], v[56:59], a[232:235]
    v_exp_f32 v51, v51
    v_mfma_f32_16x16x32_bf16 v[128:131], a[160:163], v[56:59], v[128:131]
    v_exp_f32 v52, v52
    v_mfma_f32_16x16x32_bf16 v[132:135], a[164:167], v[56:59], v[132:135]
    v_exp_f32 v53, v53
    v_mfma_f32_16x16x32_bf16 v[136:139], a[168:171], v[56:59], v[136:139]
    v_exp_f32 v54, v54
    v_mfma_f32_16x16x32_bf16 v[140:143], a[172:175], v[56:59], v[140:143]
    v_exp_f32 v55, v55
    v_mfma_f32_16x16x32_bf16 v[144:147], a[176:179], v[56:59], v[144:147]
    v_cvt_pk_bf16_f32 v60, v48, v49
    v_cvt_pk_bf16_f32 v61, v50, v51
    v_mfma_f32_16x16x32_bf16 v[148:151], a[180:183], v[56:59], v[148:151]
    v_cvt_pk_bf16_f32 v62, v52, v53
    v_cvt_pk_bf16_f32 v63, v54, v55
    v_mfma_f32_16x16x32_bf16 v[152:155], a[184:187], v[56:59], v[152:155]
    v_mfma_f32_16x16x32_bf16 v[156:159], a[188:191], v[56:59], v[156:159]
    v_mfma_f32_16x16x32_bf16 v[40:43], a[96:99], a[48:51], v[28:31]
    v_mfma_f32_16x16x32_bf16 v[40:43], a[100:103], a[52:55], v[40:43]
    v_mfma_f32_16x16x32_bf16 v[40:43], a[104:107], a[56:59], v[40:43]
    v_mfma_f32_16x16x32_bf16 v[40:43], a[108:111], a[60:63], v[40:43]
    v_mfma_f32_16x16x32_bf16 v[44:47], a[112:115], a[48:51], v[28:31]
    v_mfma_f32_16x16x32_bf16 v[44:47], a[116:119], a[52:55], v[44:47]
    v_mfma_f32_16x16x32_bf16 v[44:47], a[120:123], a[56:59], v[44:47]
    v_mfma_f32_16x16x32_bf16 v[44:47], a[124:127], a[60:63], v[44:47]
    v_mfma_f32_16x16x32_bf16 a[232:235], a[248:251], v[60:63], a[232:235]
    v_mfma_f32_16x16x32_bf16 v[128:131], a[192:195], v[60:63], v[128:131]
    v_mfma_f32_16x16x32_bf16 v[132:135], a[196:199], v[60:63], v[132:135]
    s_nop 0
    v_exp_f32 v40, v40
    v_mfma_f32_16x16x32_bf16 v[136:139], a[200:203], v[60:63], v[136:139]
    v_exp_f32 v41, v41
    v_mfma_f32_16x16x32_bf16 v[140:143], a[204:207], v[60:63], v[140:143]
    v_exp_f32 v42, v42
    v_mfma_f32_16x16x32_bf16 v[144:147], a[208:211], v[60:63], v[144:147]
    v_accvgpr_read_b32 v24, a232
    v_add_f32 v15, v15, v24
    v_mfma_f32_16x16x32_bf16 v[148:151], a[212:215], v[60:63], v[148:151]
    v_rcp_f32 v24, v24
    v_mfma_f32_16x16x32_bf16 v[152:155], a[216:219], v[60:63], v[152:155]
    v_mul_f32 v25, s34, v24
    v_cvt_pk_bf16_f32 v56, v40, v41
    v_mfma_f32_16x16x32_bf16 v[156:159], a[220:223], v[60:63], v[156:159]
    v_exp_f32 v43, v43
    v_mfma_f32_16x16x32_bf16 v[48:51], a[128:131], a[48:51], v[28:31]
    v_exp_f32 v44, v44
    v_mfma_f32_16x16x32_bf16 v[48:51], a[132:135], a[52:55], v[48:51]
    v_exp_f32 v45, v45
    v_mfma_f32_16x16x32_bf16 v[48:51], a[136:139], a[56:59], v[48:51]
    v_exp_f32 v46, v46
    v_mfma_f32_16x16x32_bf16 v[48:51], a[140:143], a[60:63], v[48:51]
    v_exp_f32 v47, v47
    v_pk_fma_f32 v[128:129], v[128:129], v[24:25], v[24:25] op_sel:[0,0,1] op_sel_hi:[1,0,1] neg_lo:[0,0,1] neg_hi:[0,0,1]
    v_pk_fma_f32 v[130:131], v[130:131], v[24:25], v[24:25] op_sel:[0,0,1] op_sel_hi:[1,0,1] neg_lo:[0,0,1] neg_hi:[0,0,1]
    v_pk_fma_f32 v[132:133], v[132:133], v[24:25], v[24:25] op_sel:[0,0,1] op_sel_hi:[1,0,1] neg_lo:[0,0,1] neg_hi:[0,0,1]
    v_pk_fma_f32 v[134:135], v[134:135], v[24:25], v[24:25] op_sel:[0,0,1] op_sel_hi:[1,0,1] neg_lo:[0,0,1] neg_hi:[0,0,1]
    v_pk_fma_f32 v[136:137], v[136:137], v[24:25], v[24:25] op_sel:[0,0,1] op_sel_hi:[1,0,1] neg_lo:[0,0,1] neg_hi:[0,0,1]
    v_pk_fma_f32 v[138:139], v[138:139], v[24:25], v[24:25] op_sel:[0,0,1] op_sel_hi:[1,0,1] neg_lo:[0,0,1] neg_hi:[0,0,1]
    v_pk_fma_f32 v[140:141], v[140:141], v[24:25], v[24:25] op_sel:[0,0,1] op_sel_hi:[1,0,1] neg_lo:[0,0,1] neg_hi:[0,0,1]
    v_pk_fma_f32 v[142:143], v[142:143], v[24:25], v[24:25] op_sel:[0,0,1] op_sel_hi:[1,0,1] neg_lo:[0,0,1] neg_hi:[0,0,1]
    v_pk_fma_f32 v[144:145], v[144:145], v[24:25], v[24:25] op_sel:[0,0,1] op_sel_hi:[1,0,1] neg_lo:[0,0,1] neg_hi:[0,0,1]
    v_pk_fma_f32 v[146:147], v[146:147], v[24:25], v[24:25] op_sel:[0,0,1] op_sel_hi:[1,0,1] neg_lo:[0,0,1] neg_hi:[0,0,1]
    v_pk_fma_f32 v[148:149], v[148:149], v[24:25], v[24:25] op_sel:[0,0,1] op_sel_hi:[1,0,1] neg_lo:[0,0,1] neg_hi:[0,0,1]
    v_pk_fma_f32 v[150:151], v[150:151], v[24:25], v[24:25] op_sel:[0,0,1] op_sel_hi:[1,0,1] neg_lo:[0,0,1] neg_hi:[0,0,1]
    v_pk_fma_f32 v[152:153], v[152:153], v[24:25], v[24:25] op_sel:[0,0,1] op_sel_hi:[1,0,1] neg_lo:[0,0,1] neg_hi:[0,0,1]
    v_pk_fma_f32 v[154:155], v[154:155], v[24:25], v[24:25] op_sel:[0,0,1] op_sel_hi:[1,0,1] neg_lo:[0,0,1] neg_hi:[0,0,1]
    v_pk_fma_f32 v[156:157], v[156:157], v[24:25], v[24:25] op_sel:[0,0,1] op_sel_hi:[1,0,1] neg_lo:[0,0,1] neg_hi:[0,0,1]
    v_pk_fma_f32 v[158:159], v[158:159], v[24:25], v[24:25] op_sel:[0,0,1] op_sel_hi:[1,0,1] neg_lo:[0,0,1] neg_hi:[0,0,1]
    v_mfma_f32_16x16x32_bf16 v[52:55], a[144:147], a[48:51], v[28:31]
    v_cvt_pk_bf16_f32 v128, v128, v129
    v_cvt_pk_bf16_f32 v136, v136, v137
    v_mfma_f32_16x16x32_bf16 v[52:55], a[148:151], a[52:55], v[52:55]
    v_cvt_pk_bf16_f32 v129, v130, v131
    v_cvt_pk_bf16_f32 v137, v138, v139
    v_mfma_f32_16x16x32_bf16 v[52:55], a[152:155], a[56:59], v[52:55]
    v_cvt_pk_bf16_f32 v130, v132, v133
    v_cvt_pk_bf16_f32 v131, v134, v135
    v_mfma_f32_16x16x32_bf16 v[52:55], a[156:159], a[60:63], v[52:55]
    v_cvt_pk_bf16_f32 v138, v140, v141
    v_cvt_pk_bf16_f32 v139, v142, v143
    v_cndmask_b32_dpp v132, v136, v128, vcc quad_perm:[1,0,3,2] row_mask:0xf bank_mask:0xf
    v_cndmask_b32_dpp v134, v138, v130, vcc quad_perm:[1,0,3,2] row_mask:0xf bank_mask:0xf
    v_cvt_pk_bf16_f32 v144, v144, v145
    v_cvt_pk_bf16_f32 v152, v152, v153
    v_cndmask_b32_dpp v133, v137, v129, vcc quad_perm:[1,0,3,2] row_mask:0xf bank_mask:0xf
    v_cndmask_b32_dpp v135, v139, v131, vcc quad_perm:[1,0,3,2] row_mask:0xf bank_mask:0xf
    buffer_store_dwordx4 v[132:135], v3, s[16:19], s29 offen offset:0 sc0 sc1 nt
    s_not_b64 vcc, vcc
    v_cvt_pk_bf16_f32 v145, v146, v147
    v_cvt_pk_bf16_f32 v153, v154, v155
    v_cndmask_b32_dpp v136, v128, v136, vcc quad_perm:[1,0,3,2] row_mask:0xf bank_mask:0xf
    v_cndmask_b32_dpp v137, v129, v137, vcc quad_perm:[1,0,3,2] row_mask:0xf bank_mask:0xf
    v_cvt_pk_bf16_f32 v146, v148, v149
    v_cvt_pk_bf16_f32 v147, v150, v151
    v_cndmask_b32_dpp v138, v130, v138, vcc quad_perm:[1,0,3,2] row_mask:0xf bank_mask:0xf
    v_cndmask_b32_dpp v139, v131, v139, vcc quad_perm:[1,0,3,2] row_mask:0xf bank_mask:0xf
    buffer_store_dwordx4 v[136:139], v3, s[16:19], s29 offen offset:256 sc0 sc1 nt
    v_cvt_pk_bf16_f32 v154, v156, v157
    v_cvt_pk_bf16_f32 v155, v158, v159
    s_not_b64 vcc, vcc
    v_cndmask_b32_dpp v148, v152, v144, vcc quad_perm:[1,0,3,2] row_mask:0xf bank_mask:0xf
    v_cndmask_b32_dpp v150, v154, v146, vcc quad_perm:[1,0,3,2] row_mask:0xf bank_mask:0xf
    v_cvt_pk_bf16_f32 v57, v42, v43
    v_cvt_pk_bf16_f32 v58, v44, v45
    v_cndmask_b32_dpp v149, v153, v145, vcc quad_perm:[1,0,3,2] row_mask:0xf bank_mask:0xf
    v_cndmask_b32_dpp v151, v155, v147, vcc quad_perm:[1,0,3,2] row_mask:0xf bank_mask:0xf
    buffer_store_dwordx4 v[148:151], v3, s[16:19], s29 offen offset:128 sc0 sc1 nt
    s_not_b64 vcc, vcc
    v_cvt_pk_bf16_f32 v59, v46, v47
    v_exp_f32 v48, v48
    v_cndmask_b32_dpp v152, v144, v152, vcc quad_perm:[1,0,3,2] row_mask:0xf bank_mask:0xf
    v_cndmask_b32_dpp v153, v145, v153, vcc quad_perm:[1,0,3,2] row_mask:0xf bank_mask:0xf
    v_exp_f32 v49, v49
    v_exp_f32 v50, v50
    v_cndmask_b32_dpp v154, v146, v154, vcc quad_perm:[1,0,3,2] row_mask:0xf bank_mask:0xf
    v_cndmask_b32_dpp v155, v147, v155, vcc quad_perm:[1,0,3,2] row_mask:0xf bank_mask:0xf
    buffer_store_dwordx4 v[152:155], v3, s[16:19], s29 offen offset:384 sc0 sc1 nt
    s_not_b64 vcc, vcc
    s_add_u32 s29, s29, 4096
    v_mfma_f32_16x16x32_bf16 a[236:239], a[248:251], v[56:59], a[236:239]
    v_exp_f32 v51, v51
    v_mfma_f32_16x16x32_bf16 v[160:163], a[160:163], v[56:59], v[160:163]
    v_exp_f32 v52, v52
    v_mfma_f32_16x16x32_bf16 v[164:167], a[164:167], v[56:59], v[164:167]
    v_exp_f32 v53, v53
    v_mfma_f32_16x16x32_bf16 v[168:171], a[168:171], v[56:59], v[168:171]
    v_exp_f32 v54, v54
    v_mfma_f32_16x16x32_bf16 v[172:175], a[172:175], v[56:59], v[172:175]
    v_exp_f32 v55, v55
    v_mfma_f32_16x16x32_bf16 v[176:179], a[176:179], v[56:59], v[176:179]
    v_cvt_pk_bf16_f32 v60, v48, v49
    v_cvt_pk_bf16_f32 v61, v50, v51
    v_mfma_f32_16x16x32_bf16 v[180:183], a[180:183], v[56:59], v[180:183]
    v_cvt_pk_bf16_f32 v62, v52, v53
    v_cvt_pk_bf16_f32 v63, v54, v55
    v_mfma_f32_16x16x32_bf16 v[184:187], a[184:187], v[56:59], v[184:187]
    v_mfma_f32_16x16x32_bf16 v[188:191], a[188:191], v[56:59], v[188:191]
    v_mfma_f32_16x16x32_bf16 v[40:43], a[96:99], a[64:67], v[32:35]
    v_mfma_f32_16x16x32_bf16 v[40:43], a[100:103], a[68:71], v[40:43]
    v_mfma_f32_16x16x32_bf16 v[40:43], a[104:107], a[72:75], v[40:43]
    v_mfma_f32_16x16x32_bf16 v[40:43], a[108:111], a[76:79], v[40:43]
    v_mfma_f32_16x16x32_bf16 v[44:47], a[112:115], a[64:67], v[32:35]
    v_mfma_f32_16x16x32_bf16 v[44:47], a[116:119], a[68:71], v[44:47]
    v_mfma_f32_16x16x32_bf16 v[44:47], a[120:123], a[72:75], v[44:47]
    v_mfma_f32_16x16x32_bf16 v[44:47], a[124:127], a[76:79], v[44:47]
    v_mfma_f32_16x16x32_bf16 a[236:239], a[248:251], v[60:63], a[236:239]
    v_mfma_f32_16x16x32_bf16 v[160:163], a[192:195], v[60:63], v[160:163]
    v_mfma_f32_16x16x32_bf16 v[164:167], a[196:199], v[60:63], v[164:167]
    s_nop 0
    v_exp_f32 v40, v40
    v_mfma_f32_16x16x32_bf16 v[168:171], a[200:203], v[60:63], v[168:171]
    v_exp_f32 v41, v41
    v_mfma_f32_16x16x32_bf16 v[172:175], a[204:207], v[60:63], v[172:175]
    v_exp_f32 v42, v42
    v_mfma_f32_16x16x32_bf16 v[176:179], a[208:211], v[60:63], v[176:179]
    v_exp_f32 v43, v43
    v_mfma_f32_16x16x32_bf16 v[180:183], a[212:215], v[60:63], v[180:183]
    v_exp_f32 v44, v44
    v_mfma_f32_16x16x32_bf16 v[184:187], a[216:219], v[60:63], v[184:187]
    v_exp_f32 v45, v45
    v_mfma_f32_16x16x32_bf16 v[188:191], a[220:223], v[60:63], v[188:191]
    v_exp_f32 v46, v46
    v_mfma_f32_16x16x32_bf16 v[48:51], a[128:131], a[64:67], v[32:35]
    v_exp_f32 v47, v47
    v_mfma_f32_16x16x32_bf16 v[48:51], a[132:135], a[68:71], v[48:51]
    v_cvt_pk_bf16_f32 v56, v40, v41
    v_cvt_pk_bf16_f32 v57, v42, v43
    v_mfma_f32_16x16x32_bf16 v[48:51], a[136:139], a[72:75], v[48:51]
    v_cvt_pk_bf16_f32 v58, v44, v45
    v_cvt_pk_bf16_f32 v59, v46, v47
    v_mfma_f32_16x16x32_bf16 v[48:51], a[140:143], a[76:79], v[48:51]
    v_accvgpr_read_b32 v28, a236
    v_add_f32 v15, v15, v28
    v_mfma_f32_16x16x32_bf16 v[52:55], a[144:147], a[64:67], v[32:35]
    v_rcp_f32 v28, v28
    v_mfma_f32_16x16x32_bf16 v[52:55], a[148:151], a[68:71], v[52:55]
    v_mul_f32 v29, s34, v28
    v_mfma_f32_16x16x32_bf16 v[52:55], a[152:155], a[72:75], v[52:55]
    s_nop 0
    v_exp_f32 v48, v48
    v_pk_fma_f32 v[160:161], v[160:161], v[28:29], v[28:29] op_sel:[0,0,1] op_sel_hi:[1,0,1] neg_lo:[0,0,1] neg_hi:[0,0,1]
    v_pk_fma_f32 v[162:163], v[162:163], v[28:29], v[28:29] op_sel:[0,0,1] op_sel_hi:[1,0,1] neg_lo:[0,0,1] neg_hi:[0,0,1]
    v_pk_fma_f32 v[164:165], v[164:165], v[28:29], v[28:29] op_sel:[0,0,1] op_sel_hi:[1,0,1] neg_lo:[0,0,1] neg_hi:[0,0,1]
    v_pk_fma_f32 v[166:167], v[166:167], v[28:29], v[28:29] op_sel:[0,0,1] op_sel_hi:[1,0,1] neg_lo:[0,0,1] neg_hi:[0,0,1]
    v_pk_fma_f32 v[168:169], v[168:169], v[28:29], v[28:29] op_sel:[0,0,1] op_sel_hi:[1,0,1] neg_lo:[0,0,1] neg_hi:[0,0,1]
    v_pk_fma_f32 v[170:171], v[170:171], v[28:29], v[28:29] op_sel:[0,0,1] op_sel_hi:[1,0,1] neg_lo:[0,0,1] neg_hi:[0,0,1]
    v_pk_fma_f32 v[172:173], v[172:173], v[28:29], v[28:29] op_sel:[0,0,1] op_sel_hi:[1,0,1] neg_lo:[0,0,1] neg_hi:[0,0,1]
    v_pk_fma_f32 v[174:175], v[174:175], v[28:29], v[28:29] op_sel:[0,0,1] op_sel_hi:[1,0,1] neg_lo:[0,0,1] neg_hi:[0,0,1]
    v_pk_fma_f32 v[176:177], v[176:177], v[28:29], v[28:29] op_sel:[0,0,1] op_sel_hi:[1,0,1] neg_lo:[0,0,1] neg_hi:[0,0,1]
    v_pk_fma_f32 v[178:179], v[178:179], v[28:29], v[28:29] op_sel:[0,0,1] op_sel_hi:[1,0,1] neg_lo:[0,0,1] neg_hi:[0,0,1]
    v_pk_fma_f32 v[180:181], v[180:181], v[28:29], v[28:29] op_sel:[0,0,1] op_sel_hi:[1,0,1] neg_lo:[0,0,1] neg_hi:[0,0,1]
    v_pk_fma_f32 v[182:183], v[182:183], v[28:29], v[28:29] op_sel:[0,0,1] op_sel_hi:[1,0,1] neg_lo:[0,0,1] neg_hi:[0,0,1]
    v_pk_fma_f32 v[184:185], v[184:185], v[28:29], v[28:29] op_sel:[0,0,1] op_sel_hi:[1,0,1] neg_lo:[0,0,1] neg_hi:[0,0,1]
    v_pk_fma_f32 v[186:187], v[186:187], v[28:29], v[28:29] op_sel:[0,0,1] op_sel_hi:[1,0,1] neg_lo:[0,0,1] neg_hi:[0,0,1]
    v_pk_fma_f32 v[188:189], v[188:189], v[28:29], v[28:29] op_sel:[0,0,1] op_sel_hi:[1,0,1] neg_lo:[0,0,1] neg_hi:[0,0,1]
    v_pk_fma_f32 v[190:191], v[190:191], v[28:29], v[28:29] op_sel:[0,0,1] op_sel_hi:[1,0,1] neg_lo:[0,0,1] neg_hi:[0,0,1]
    v_mfma_f32_16x16x32_bf16 v[52:55], a[156:159], a[76:79], v[52:55]
    v_cvt_pk_bf16_f32 v160, v160, v161
    v_cvt_pk_bf16_f32 v168, v168, v169
    v_mfma_f32_16x16x32_bf16 a[240:243], a[248:251], v[56:59], a[240:243]
    v_cvt_pk_bf16_f32 v161, v162, v163
    v_cvt_pk_bf16_f32 v169, v170, v171
    v_mfma_f32_16x16x32_bf16 v[192:195], a[160:163], v[56:59], v[192:195]
    v_cvt_pk_bf16_f32 v162, v164, v165
    v_cvt_pk_bf16_f32 v163, v166, v167
    v_mfma_f32_16x16x32_bf16 v[196:199], a[164:167], v[56:59], v[196:199]
    v_cvt_pk_bf16_f32 v170, v172, v173
    v_cvt_pk_bf16_f32 v171, v174, v175
    v_mfma_f32_16x16x32_bf16 v[200:203], a[168:171], v[56:59], v[200:203]
    v_cndmask_b32_dpp v164, v168, v160, vcc quad_perm:[1,0,3,2] row_mask:0xf bank_mask:0xf
    v_cndmask_b32_dpp v166, v170, v162, vcc quad_perm:[1,0,3,2] row_mask:0xf bank_mask:0xf
    v_mfma_f32_16x16x32_bf16 v[204:207], a[172:175], v[56:59], v[204:207]
    v_cndmask_b32_dpp v165, v169, v161, vcc quad_perm:[1,0,3,2] row_mask:0xf bank_mask:0xf
    v_cndmask_b32_dpp v167, v171, v163, vcc quad_perm:[1,0,3,2] row_mask:0xf bank_mask:0xf
    v_mfma_f32_16x16x32_bf16 v[208:211], a[176:179], v[56:59], v[208:211]
    buffer_store_dwordx4 v[164:167], v3, s[16:19], s29 offen offset:0 sc0 sc1 nt
    v_mfma_f32_16x16x32_bf16 v[212:215], a[180:183], v[56:59], v[212:215]
    s_not_b64 vcc, vcc
    v_exp_f32 v49, v49
    v_mfma_f32_16x16x32_bf16 v[216:219], a[184:187], v[56:59], v[216:219]
    v_exp_f32 v50, v50
    v_mfma_f32_16x16x32_bf16 v[220:223], a[188:191], v[56:59], v[220:223]
    v_exp_f32 v51, v51
    v_exp_f32 v52, v52
    v_exp_f32 v53, v53
    v_exp_f32 v54, v54
    v_exp_f32 v55, v55
    v_cvt_pk_bf16_f32 v60, v48, v49
    v_cvt_pk_bf16_f32 v61, v50, v51
    v_cvt_pk_bf16_f32 v62, v52, v53
    v_cvt_pk_bf16_f32 v63, v54, v55
    v_cndmask_b32_dpp v168, v160, v168, vcc quad_perm:[1,0,3,2] row_mask:0xf bank_mask:0xf
    v_cndmask_b32_dpp v169, v161, v169, vcc quad_perm:[1,0,3,2] row_mask:0xf bank_mask:0xf
    v_mfma_f32_16x16x32_bf16 a[240:243], a[248:251], v[60:63], a[240:243]
    v_cndmask_b32_dpp v170, v162, v170, vcc quad_perm:[1,0,3,2] row_mask:0xf bank_mask:0xf
    v_cndmask_b32_dpp v171, v163, v171, vcc quad_perm:[1,0,3,2] row_mask:0xf bank_mask:0xf
    v_mfma_f32_16x16x32_bf16 v[192:195], a[192:195], v[60:63], v[192:195]
    buffer_store_dwordx4 v[168:171], v3, s[16:19], s29 offen offset:256 sc0 sc1 nt
    v_mfma_f32_16x16x32_bf16 v[196:199], a[196:199], v[60:63], v[196:199]
    s_not_b64 vcc, vcc
    v_cvt_pk_bf16_f32 v176, v176, v177
    v_cvt_pk_bf16_f32 v184, v184, v185
    v_mfma_f32_16x16x32_bf16 v[200:203], a[200:203], v[60:63], v[200:203]
    v_cvt_pk_bf16_f32 v177, v178, v179
    v_cvt_pk_bf16_f32 v185, v186, v187
    v_mfma_f32_16x16x32_bf16 v[204:207], a[204:207], v[60:63], v[204:207]
    v_cvt_pk_bf16_f32 v178, v180, v181
    v_cvt_pk_bf16_f32 v179, v182, v183
    v_mfma_f32_16x16x32_bf16 v[208:211], a[208:211], v[60:63], v[208:211]
    v_cvt_pk_bf16_f32 v186, v188, v189
    v_cvt_pk_bf16_f32 v187, v190, v191
    v_mfma_f32_16x16x32_bf16 v[212:215], a[212:215], v[60:63], v[212:215]
    v_cndmask_b32_dpp v180, v184, v176, vcc quad_perm:[1,0,3,2] row_mask:0xf bank_mask:0xf
    v_cndmask_b32_dpp v182, v186, v178, vcc quad_perm:[1,0,3,2] row_mask:0xf bank_mask:0xf
    v_mfma_f32_16x16x32_bf16 v[216:219], a[216:219], v[60:63], v[216:219]
    v_cndmask_b32_dpp v181, v185, v177, vcc quad_perm:[1,0,3,2] row_mask:0xf bank_mask:0xf
    v_cndmask_b32_dpp v183, v187, v179, vcc quad_perm:[1,0,3,2] row_mask:0xf bank_mask:0xf
    v_mfma_f32_16x16x32_bf16 v[220:223], a[220:223], v[60:63], v[220:223]
    buffer_store_dwordx4 v[180:183], v3, s[16:19], s29 offen offset:128 sc0 sc1 nt
    v_accvgpr_read_b32 v32, a240
    s_not_b64 vcc, vcc
    v_add_f32 v15, v15, v32
    v_cndmask_b32_dpp v184, v176, v184, vcc quad_perm:[1,0,3,2] row_mask:0xf bank_mask:0xf
    v_cndmask_b32_dpp v185, v177, v185, vcc quad_perm:[1,0,3,2] row_mask:0xf bank_mask:0xf
    v_rcp_f32 v32, v32
    v_cndmask_b32_dpp v186, v178, v186, vcc quad_perm:[1,0,3,2] row_mask:0xf bank_mask:0xf
    v_mul_f32 v33, s34, v32
    v_cndmask_b32_dpp v187, v179, v187, vcc quad_perm:[1,0,3,2] row_mask:0xf bank_mask:0xf
    buffer_store_dwordx4 v[184:187], v3, s[16:19], s29 offen offset:384 sc0 sc1 nt
    v_fma_f32 v192, v192, v32, -v33
    v_fma_f32 v193, v193, v32, -v33
    v_pk_fma_f32 v[200:201], v[200:201], v[32:33], v[32:33] op_sel:[0,0,1] op_sel_hi:[1,0,1] neg_lo:[0,0,1] neg_hi:[0,0,1]
    v_fma_f32 v194, v194, v32, -v33
    v_fma_f32 v195, v195, v32, -v33
    v_cvt_pk_bf16_f32 v192, v192, v193
    v_pk_fma_f32 v[202:203], v[202:203], v[32:33], v[32:33] op_sel:[0,0,1] op_sel_hi:[1,0,1] neg_lo:[0,0,1] neg_hi:[0,0,1]
    v_cvt_pk_bf16_f32 v200, v200, v201
    v_fma_f32 v196, v196, v32, -v33
    v_fma_f32 v197, v197, v32, -v33
    v_fma_f32 v198, v198, v32, -v33
    v_fma_f32 v199, v199, v32, -v33
    v_cvt_pk_bf16_f32 v193, v194, v195
    v_pk_fma_f32 v[204:205], v[204:205], v[32:33], v[32:33] op_sel:[0,0,1] op_sel_hi:[1,0,1] neg_lo:[0,0,1] neg_hi:[0,0,1]
    v_pk_fma_f32 v[206:207], v[206:207], v[32:33], v[32:33] op_sel:[0,0,1] op_sel_hi:[1,0,1] neg_lo:[0,0,1] neg_hi:[0,0,1]
    v_cvt_pk_bf16_f32 v201, v202, v203
    v_cvt_pk_bf16_f32 v194, v196, v197
    v_cvt_pk_bf16_f32 v195, v198, v199
    v_cvt_pk_bf16_f32 v202, v204, v205
    v_cvt_pk_bf16_f32 v203, v206, v207
    s_not_b64 vcc, vcc
    s_add_u32 s29, s29, 4096
    v_cndmask_b32_dpp v196, v200, v192, vcc quad_perm:[1,0,3,2] row_mask:0xf bank_mask:0xf
    v_cndmask_b32_dpp v198, v202, v194, vcc quad_perm:[1,0,3,2] row_mask:0xf bank_mask:0xf
    v_pk_fma_f32 v[208:209], v[208:209], v[32:33], v[32:33] op_sel:[0,0,1] op_sel_hi:[1,0,1] neg_lo:[0,0,1] neg_hi:[0,0,1]
    v_pk_fma_f32 v[216:217], v[216:217], v[32:33], v[32:33] op_sel:[0,0,1] op_sel_hi:[1,0,1] neg_lo:[0,0,1] neg_hi:[0,0,1]
    v_cndmask_b32_dpp v197, v201, v193, vcc quad_perm:[1,0,3,2] row_mask:0xf bank_mask:0xf
    v_cndmask_b32_dpp v199, v203, v195, vcc quad_perm:[1,0,3,2] row_mask:0xf bank_mask:0xf
    buffer_store_dwordx4 v[196:199], v3, s[16:19], s29 offen offset:0 sc0 sc1 nt
    s_not_b64 vcc, vcc
    v_pk_fma_f32 v[210:211], v[210:211], v[32:33], v[32:33] op_sel:[0,0,1] op_sel_hi:[1,0,1] neg_lo:[0,0,1] neg_hi:[0,0,1]
    v_cvt_pk_bf16_f32 v208, v208, v209
    v_cndmask_b32_dpp v200, v192, v200, vcc quad_perm:[1,0,3,2] row_mask:0xf bank_mask:0xf
    v_cndmask_b32_dpp v201, v193, v201, vcc quad_perm:[1,0,3,2] row_mask:0xf bank_mask:0xf
    v_pk_fma_f32 v[218:219], v[218:219], v[32:33], v[32:33] op_sel:[0,0,1] op_sel_hi:[1,0,1] neg_lo:[0,0,1] neg_hi:[0,0,1]
    v_cvt_pk_bf16_f32 v216, v216, v217
    v_cndmask_b32_dpp v202, v194, v202, vcc quad_perm:[1,0,3,2] row_mask:0xf bank_mask:0xf
    v_cndmask_b32_dpp v203, v195, v203, vcc quad_perm:[1,0,3,2] row_mask:0xf bank_mask:0xf
    buffer_store_dwordx4 v[200:203], v3, s[16:19], s29 offen offset:256 sc0 sc1 nt
    v_pk_fma_f32 v[212:213], v[212:213], v[32:33], v[32:33] op_sel:[0,0,1] op_sel_hi:[1,0,1] neg_lo:[0,0,1] neg_hi:[0,0,1]
    v_pk_fma_f32 v[214:215], v[214:215], v[32:33], v[32:33] op_sel:[0,0,1] op_sel_hi:[1,0,1] neg_lo:[0,0,1] neg_hi:[0,0,1]
    v_cvt_pk_bf16_f32 v209, v210, v211
    v_pk_fma_f32 v[220:221], v[220:221], v[32:33], v[32:33] op_sel:[0,0,1] op_sel_hi:[1,0,1] neg_lo:[0,0,1] neg_hi:[0,0,1]
    v_pk_fma_f32 v[222:223], v[222:223], v[32:33], v[32:33] op_sel:[0,0,1] op_sel_hi:[1,0,1] neg_lo:[0,0,1] neg_hi:[0,0,1]
    v_cvt_pk_bf16_f32 v217, v218, v219
    v_cvt_pk_bf16_f32 v210, v212, v213
    v_cvt_pk_bf16_f32 v211, v214, v215
    v_cvt_pk_bf16_f32 v218, v220, v221
    v_cvt_pk_bf16_f32 v219, v222, v223
    s_not_b64 vcc, vcc
    v_cndmask_b32_dpp v212, v216, v208, vcc quad_perm:[1,0,3,2] row_mask:0xf bank_mask:0xf
    v_cndmask_b32_dpp v214, v218, v210, vcc quad_perm:[1,0,3,2] row_mask:0xf bank_mask:0xf
    v_cndmask_b32_dpp v213, v217, v209, vcc quad_perm:[1,0,3,2] row_mask:0xf bank_mask:0xf
    v_cndmask_b32_dpp v215, v219, v211, vcc quad_perm:[1,0,3,2] row_mask:0xf bank_mask:0xf
    buffer_store_dwordx4 v[212:215], v3, s[16:19], s29 offen offset:128 sc0 sc1 nt
    s_not_b64 vcc, vcc
    v_cndmask_b32_dpp v216, v208, v216, vcc quad_perm:[1,0,3,2] row_mask:0xf bank_mask:0xf
    v_cndmask_b32_dpp v217, v209, v217, vcc quad_perm:[1,0,3,2] row_mask:0xf bank_mask:0xf
    v_cndmask_b32_dpp v218, v210, v218, vcc quad_perm:[1,0,3,2] row_mask:0xf bank_mask:0xf
    v_cndmask_b32_dpp v219, v211, v219, vcc quad_perm:[1,0,3,2] row_mask:0xf bank_mask:0xf
    buffer_store_dwordx4 v[216:219], v3, s[16:19], s29 offen offset:384 sc0 sc1 nt
    s_not_b64 vcc, vcc
    s_add_u32 s29, s29, 4096
    s_lshl_b32 s26, s20, 13
    s_add_u32 s26, s26, 0x20000
    s_mov_b32 s27, 0x46000000
    v_cmp_ngt_f32 vcc, s27, v15
    s_cmp_lg_u64 vcc, 0
    s_cselect_b32 s27, 1, 0
    v_mbcnt_lo_u32_b32 v4, -1, 0
    v_mbcnt_hi_u32_b32 v4, -1, v4
    v_mov_b32 v5, s27
    v_mov_b32 v6, s26
    ds_write_b32 v6, v5 offset:6144
    v_and_b32 v6, 3, v4
    v_lshlrev_b32 v6, 13, v6
    v_add_u32 v6, 0x20000, v6
    s_waitcnt lgkmcnt(0)
    s_barrier
    ds_read_b32 v5, v6 offset:6144
    s_waitcnt lgkmcnt(0)
    v_cmp_ne_u32 vcc, 0, v5
    s_cmp_lg_u32 s25, 0
    s_cbranch_scc1 L_fin
    s_cbranch_vccz L_fin
    s_waitcnt vmcnt(0)
    s_barrier
    s_mov_b32 s25, 1
    v_and_b32 v6, 15, v4
    v_lshlrev_b32 v6, 8, v6
    v_lshrrev_b32 v5, 4, v4
    v_lshl_add_u32 v6, v5, 4, v6
    v_mov_b32 v128, 0xff800000
    v_mov_b32 v129, 0xff800000
    v_mov_b32 v130, 0xff800000
    v_mov_b32 v131, 0xff800000
    v_mov_b32 v132, 0xff800000
    s_mov_b32 s26, 0
L_max5:
    buffer_load_dwordx4 a[96:99], v6, s[8:11], s26 offen offset:0
    buffer_load_dwordx4 a[100:103], v6, s[8:11], s26 offen offset:64
    buffer_load_dwordx4 a[104:107], v6, s[8:11], s26 offen offset:128
    buffer_load_dwordx4 a[108:111], v6, s[8:11], s26 offen offset:192
    s_waitcnt vmcnt(0)
    v_mfma_f32_16x16x32_bf16 v[64:67], a[96:99], a[0:3], 0
    v_mfma_f32_16x16x32_bf16 v[64:67], a[100:103], a[4:7], v[64:67]
    v_mfma_f32_16x16x32_bf16 v[64:67], a[104:107], a[8:11], v[64:67]
    v_mfma_f32_16x16x32_bf16 v[64:67], a[108:111], a[12:15], v[64:67]
    v_mfma_f32_16x16x32_bf16 v[68:71], a[96:99], a[16:19], 0
    v_mfma_f32_16x16x32_bf16 v[68:71], a[100:103], a[20:23], v[68:71]
    v_mfma_f32_16x16x32_bf16 v[68:71], a[104:107], a[24:27], v[68:71]
    v_mfma_f32_16x16x32_bf16 v[68:71], a[108:111], a[28:31], v[68:71]
    v_mfma_f32_16x16x32_bf16 v[72:75], a[96:99], a[32:35], 0
    v_mfma_f32_16x16x32_bf16 v[72:75], a[100:103], a[36:39], v[72:75]
    v_mfma_f32_16x16x32_bf16 v[72:75], a[104:107], a[40:43], v[72:75]
    v_mfma_f32_16x16x32_bf16 v[72:75], a[108:111], a[44:47], v[72:75]
    v_mfma_f32_16x16x32_bf16 v[76:79], a[96:99], a[48:51], 0
    v_mfma_f32_16x16x32_bf16 v[76:79], a[100:103], a[52:55], v[76:79]
    v_mfma_f32_16x16x32_bf16 v[76:79], a[104:107], a[56:59], v[76:79]
    v_mfma_f32_16x16x32_bf16 v[76:79], a[108:111], a[60:63], v[76:79]
    v_mfma_f32_16x16x32_bf16 v[80:83], a[96:99], a[64:67], 0
    v_mfma_f32_16x16x32_bf16 v[80:83], a[100:103], a[68:71], v[80:83]
    v_mfma_f32_16x16x32_bf16 v[80:83], a[104:107], a[72:75], v[80:83]
    v_mfma_f32_16x16x32_bf16 v[80:83], a[108:111], a[76:79], v[80:83]
    s_nop 7
    v_max3_f32 v128, v128, v64, v65
    v_max3_f32 v128, v128, v66, v67
    v_max3_f32 v129, v129, v68, v69
    v_max3_f32 v129, v129, v70, v71
    v_max3_f32 v130, v130, v72, v73
    v_max3_f32 v130, v130, v74, v75
    v_max3_f32 v131, v131, v76, v77
    v_max3_f32 v131, v131, v78, v79
    v_max3_f32 v132, v132, v80, v81
    v_max3_f32 v132, v132, v82, v83
    s_add_u32 s26, s26, 4096
    s_cmp_lt_u32 s26, 0x40000
    s_cbranch_scc1 L_max5
    v_mov_b32 v5, v128
    s_nop 1
    v_permlane32_swap_b32 v128, v5
    v_max_f32 v128, v128, v5
    v_mov_b32 v5, v128
    s_nop 1
    v_permlane16_swap_b32 v128, v5
    v_max_f32 v128, v128, v5
    v_sub_f32 v16, 0, v128
    v_mov_b32 v5, v129
    s_nop 1
    v_permlane32_swap_b32 v129, v5
    v_max_f32 v129, v129, v5
    v_mov_b32 v5, v129
    s_nop 1
    v_permlane16_swap_b32 v129, v5
    v_max_f32 v129, v129, v5
    v_sub_f32 v20, 0, v129
    v_mov_b32 v5, v130
    s_nop 1
    v_permlane32_swap_b32 v130, v5
    v_max_f32 v130, v130, v5
    v_mov_b32 v5, v130
    s_nop 1
    v_permlane16_swap_b32 v130, v5
    v_max_f32 v130, v130, v5
    v_sub_f32 v24, 0, v130
    v_mov_b32 v5, v131
    s_nop 1
    v_permlane32_swap_b32 v131, v5
    v_max_f32 v131, v131, v5
    v_mov_b32 v5, v131
    s_nop 1
    v_permlane16_swap_b32 v131, v5
    v_max_f32 v131, v131, v5
    v_sub_f32 v28, 0, v131
    v_mov_b32 v5, v132
    s_nop 1
    v_permlane32_swap_b32 v132, v5
    v_max_f32 v132, v132, v5
    v_mov_b32 v5, v132
    s_nop 1
    v_permlane16_swap_b32 v132, v5
    v_max_f32 v132, v132, v5
    v_sub_f32 v32, 0, v132
    v_mbcnt_lo_u32_b32 v0, -1, 0
    v_mbcnt_hi_u32_b32 v0, -1, v0
    s_and_b32 s26, s20, 1
    s_lshl_b32 s23, s26, 5
    v_lshrrev_b32 v1, 4, v0
    v_lshlrev_b32 v3, 2, v1
    v_xor_b32 v3, v3, v0
    v_and_b32 v3, 15, v3
    v_lshlrev_b32 v3, 4, v3
    v_lshl_add_u32 v3, v1, 8, v3
    v_xor_b32 v3, s23, v3
    v_xor_b32 v234, 32, v3
    s_and_b32 s27, s20, 2
    s_lshl1_add_u32 s26, s27, s26
    s_lshl_b32 s26, s26, 10
    s_add_u32 s27, s26, 8192
    s_add_u32 s21, s26, 16384
    s_mul_i32 s29, s20, 24576
    s_lshl_b32 s28, s20, 12
    s_add_u32 m0, s28, 0x8000
    s_nop 0
    buffer_load_dwordx4 v3, s[4:7], s29 offen offset:0 nt lds
    buffer_load_dwordx4 v234, s[4:7], s29 offen offset:1024 nt lds
    buffer_load_dwordx4 v3, s[4:7], s29 offen offset:2048 nt lds
    buffer_load_dwordx4 v234, s[4:7], s29 offen offset:3072 nt lds
    s_add_u32 s29, s29, 4096
    s_add_u32 m0, s26, 0x0
    s_nop 0
    buffer_load_dwordx4 v3, s[8:11], s26 offen nt lds
    buffer_load_dwordx4 v3, s[8:11], s26 offen offset:2048 nt lds
    s_add_u32 m0, s27, 0x0
    s_nop 0
    buffer_load_dwordx4 v3, s[8:11], s27 offen nt lds
    buffer_load_dwordx4 v3, s[8:11], s27 offen offset:2048 nt lds
    s_branch L_restart
L_fin:
L_end:
    s_endpgm
.section .rodata,"a"
.p2align 6
.amdhsa_kernel standalone__mha_softmax__near_ridge_kernel
  .amdhsa_next_free_vgpr 512
  .amdhsa_next_free_sgpr 102
  .amdhsa_accum_offset 256
  .amdhsa_group_segment_fixed_size 0
  .amdhsa_kernarg_size 48
  .amdhsa_user_sgpr_count 2
  .amdhsa_user_sgpr_kernarg_segment_ptr 1
  .amdhsa_system_sgpr_workgroup_id_x 1
.end_amdhsa_kernel
```
